```python
import torch

def _softmax(x, axis=-1):
    return torch.softmax(x, dim=axis)
def _gelu(x):
    return torch.nn.functional.gelu(x, approximate="tanh")
def _silu(x):
    return torch.nn.functional.silu(x)
def _sigmoid(x):
    return torch.sigmoid(x)
def _layernorm(x, axis=-1, eps=1e-5):
    m = x.mean(dim=axis, keepdim=True)
    v = x.var(dim=axis, keepdim=True, unbiased=False)
    return (x - m) / torch.sqrt(v + eps)
def _scatter_add(tgt, idx, src, axis=0):
    return tgt.clone().index_add_(axis, idx, src)
def _segment_sum(src, seg, n):
    out = torch.zeros((n,) + src.shape[1:], dtype=src.dtype)
    return out.index_add_(0, seg, src)
def _pad(x, pw):
    flat = tuple(v for pair in reversed(pw) for v in pair)
    return torch.nn.functional.pad(x, flat)

kernel_name = 'concat_heads__mha_block_cached__gqa_block_cached__near_ridge'

def setup_inputs():

    _w = (lambda a: (lambda t: t.to(torch.bfloat16) if t.is_floating_point() else t)(torch.as_tensor(a)))
    def _A_setup():
        B, Sq, D = 32, 48, 512
        H, Sk, Dh = 32, 48, 128
        return {
            "x": _w((lambda *s: torch.randn(*s, dtype=torch.bfloat16) * 0.8)(B, Sq, D)),
            "k_cache": _w((lambda *s: torch.randn(*s, dtype=torch.bfloat16) * 0.8)(B, H, Sk, Dh)),
            "v_cache": _w((lambda *s: torch.randn(*s, dtype=torch.bfloat16) * 0.05)(B, H, Sk, Dh)),
            "wq": _w((lambda *s: torch.randn(*s, dtype=torch.bfloat16) * 0.8)(D, H * Dh) * (D ** -0.5)),
            "wo": _w((lambda *s: torch.randn(*s, dtype=torch.bfloat16) * 0.05)(H * Dh, D) * ((H * Dh) ** -0.5)),
        }
    _A_in = _A_setup()

    def _B_setup():
        B, Sq, D = 32, 48, 512
        Hq, Hkv, Sk, Dh = 32, 32, 48, 128
        assert Hq % Hkv == 0, (Hq, Hkv)
        return {
            "x": _w((lambda *s: torch.randn(*s, dtype=torch.bfloat16) * 0.8)(B, Sq, D)),
            "k_cache": _w((lambda *s: torch.randn(*s, dtype=torch.bfloat16) * 0.8)(B, Hkv, Sk, Dh)),
            "v_cache": _w((lambda *s: torch.randn(*s, dtype=torch.bfloat16) * 0.05)(B, Hkv, Sk, Dh)),
            "wq": _w((lambda *s: torch.randn(*s, dtype=torch.bfloat16) * 0.8)(D, Hq * Dh) * (D ** -0.5)),
            "wo": _w((lambda *s: torch.randn(*s, dtype=torch.bfloat16) * 0.05)(Hq * Dh, D) * ((Hq * Dh) ** -0.5)),
        }
    _B_in = _B_setup()

    return {
        "A_x": _A_in["x"],
        "A_k_cache": _A_in["k_cache"],
        "A_v_cache": _A_in["v_cache"],
        "A_wq": _A_in["wq"],
        "A_wo": _A_in["wo"],
        "B_x": _B_in["x"],
        "B_k_cache": _B_in["k_cache"],
        "B_v_cache": _B_in["v_cache"],
        "B_wq": _B_in["wq"],
        "B_wo": _B_in["wo"],
    }

def reference(A_x, A_k_cache, A_v_cache, A_wq, A_wo, B_x, B_k_cache, B_v_cache, B_wq, B_wo):
    def _A_ref(x, k_cache, v_cache, wq, wo):
        B, Sq, D = x.shape
        H, Dh = 32, 128
        q = (lambda x, *d: x.permute(*d))((x @ wq).reshape(B, Sq, H, Dh), 0, 2, 1, 3)
        scores = torch.einsum("bhqd,bhkd->bhqk", q, k_cache) * (Dh ** -0.5)
        p = _softmax(scores, axis=-1)
        o = torch.einsum("bhqk,bhkd->bhqd", p, v_cache)
        return (lambda x, *d: x.permute(*d))(o, 0, 2, 1, 3).reshape(B, Sq, H * Dh) @ wo

    def _B_ref(x, k_cache, v_cache, wq, wo):
        B, Sq, D = x.shape
        Hq, Dh = 32, 128
        Hkv = k_cache.shape[1]
        rep = Hq // Hkv
        q = (lambda x, *d: x.permute(*d))((x @ wq).reshape(B, Sq, Hq, Dh), 0, 2, 1, 3)
        k = (lambda x, n, axis: torch.repeat_interleave(x, n, dim=axis))(k_cache, rep, axis=1)
        v = (lambda x, n, axis: torch.repeat_interleave(x, n, dim=axis))(v_cache, rep, axis=1)
        scores = torch.einsum("bhqd,bhkd->bhqk", q, k) * (Dh ** -0.5)
        p = _softmax(scores, axis=-1)
        o = torch.einsum("bhqk,bhkd->bhqd", p, v)
        return (lambda x, *d: x.permute(*d))(o, 0, 2, 1, 3).reshape(B, Sq, Hq * Dh) @ wo

    a = _A_ref(A_x, A_k_cache, A_v_cache, A_wq, A_wo)
    b = _B_ref(B_x, B_k_cache, B_v_cache, B_wq, B_wo)
    return torch.concatenate([a, b], axis=-1)
```

```asm
; @launch grid=(256,1,1) block=(512,1,1) lds=163840
.amdgcn_target "amdgcn-amd-amdhsa--gfx950"
.text
.globl concat_heads__mha_block_cached__gqa_block_cached__near_ridge_kernel
.p2align 8
.type concat_heads__mha_block_cached__gqa_block_cached__near_ridge_kernel,@function
concat_heads__mha_block_cached__gqa_block_cached__near_ridge_kernel:
  s_cmp_ge_u32 s2, 256
  s_cbranch_scc1 Lend
  s_and_b32 s64, s2, 4
  s_mul_i32 s65, s64, 10
  s_load_dwordx2 s[24:25], s[0:1], s65
  s_add_u32 s4, s0, s65
  s_addc_u32 s5, s1, 0
  s_load_dwordx2 s[36:37], s[4:5], 24
  s_load_dwordx2 s[28:29], s[4:5], 8
  s_load_dwordx2 s[32:33], s[4:5], 16
  s_load_dwordx2 s[40:41], s[4:5], 32
  s_load_dwordx2 s[44:45], s[0:1], 80
  s_load_dwordx2 s[52:53], s[0:1], 88
  s_load_dwordx2 s[48:49], s[0:1], 96
  s_and_b32 s64, s2, 7
  s_lshr_b32 s59, s64, 2
  v_lshrrev_b32 v1, 6, v0
  v_and_b32 v0, 63, v0
  v_readfirstlane_b32 s56, v1
  s_lshr_b32 s65, s2, 3
  s_and_b32 s64, s64, 3
  s_lshl_b32 s64, s64, 1
  s_and_b32 s66, s65, 1
  s_add_u32 s57, s64, s66
  s_lshr_b32 s58, s65, 1
  s_lshl_b32 s64, s59, 4
  s_add_u32 s60, s64, s58
  s_lshr_b32 s61, s56, 2
  s_and_b32 s62, s56, 3
  s_mov_b32 s26, 1572864
  s_mov_b32 s27, 0x00020000
  s_mov_b32 s30, 12582912
  s_mov_b32 s31, 0x00020000
  s_mov_b32 s34, 12582912
  s_mov_b32 s35, 0x00020000
  s_mov_b32 s38, 4194304
  s_mov_b32 s39, 0x00020000
  s_mov_b32 s42, 4194304
  s_mov_b32 s43, 0x00020000
  s_mov_b32 s46, 3145728
  s_mov_b32 s47, 0x00020000
  s_mov_b32 s50, 268435456
  s_mov_b32 s51, 0x00020000
  s_mov_b32 s54, 256
  s_mov_b32 s55, 0x00020000
  v_lshrrev_b32 v1, 4, v0
  v_and_b32 v2, 15, v0
  v_lshrrev_b32 v3, 2, v2
  v_and_b32 v4, 3, v0
  v_lshlrev_b32 v247, 4, v0
  s_lshl_b32 s65, s61, 3
  s_add_u32 s64, s62, s65
  s_lshl_b32 s64, s64, 13
  s_lshl_b32 s65, s57, 10
  s_add_u32 s64, s64, s65
  v_add_u32 v236, s64, v247
  s_mul_i32 s63, s56, 4128
  v_lshrrev_b32 v5, 3, v0
  v_and_b32 v6, 7, v0
  s_lshl_b32 s64, s56, 3
  v_add_u32 v7, s64, v5
  v_bfe_u32 v8, v7, 1, 3
  v_xor_b32 v8, v8, v6
  v_lshlrev_b32 v8, 4, v8
  s_mul_i32 s65, s58, 98304
  v_lshl_add_u32 v8, v7, 10, v8
  v_add_u32 v237, s65, v8
  s_lshl_b32 s64, s56, 2
  s_add_u32 s64, s64, 64
  v_add_u32 v7, s64, v5
  v_bfe_u32 v8, v7, 1, 3
  v_xor_b32 v8, v8, v6
  v_lshlrev_b32 v8, 4, v8
  v_lshl_add_u32 v8, v7, 10, v8
  v_add_u32 v238, s65, v8
  s_lshl_b32 s67, s56, 10
  s_add_u32 s67, s67, 132096
  s_lshl_b32 s68, s56, 9
  s_add_u32 s68, s68, 140288
  s_mul_i32 s64, s58, 16384
  s_lshr_b32 s64, s64, 16
  s_mul_i32 s64, s64, 4
  s_sub_u32 s75, s58, s64
  s_add_u32 s9, s58, s57
  s_lshl_b32 s9, s9, 0
  s_and_b32 s9, s9, 7
  s_lshl_b32 s64, s58, 1
  s_add_u32 s64, s64, s61
  s_lshl_b32 s64, s64, 5
  s_lshl_b32 s65, s57, 2
  s_add_u32 s64, s64, s65
  s_add_u32 s64, s64, s62
  s_mul_i32 s64, s64, 12288
  v_add_u32 v239, s64, v247
  v_add_u32 v240, 8192, v239
  s_mov_b32 s6, 4096
  s_mov_b32 s7, 2048
  v_lshlrev_b32 v6, 4, v2
  v_lshl_add_u32 v7, v1, 11, v6
  v_add_u32 v241, s64, v7
  v_lshl_add_u32 v7, v1, 10, v6
  v_add_u32 v7, 8192, v7
  v_add_u32 v242, s64, v7
  s_waitcnt lgkmcnt(0)
  s_lshl_b32 s64, s60, 3
  v_mov_b32 v254, s64
  s_add_u32 m0, s67, 0
  s_add_u32 s64, s9, 0
  s_and_b32 s64, s64, 7
  s_lshl_b32 s64, s64, 7
  buffer_load_dwordx4 v237, s[24:27], s64 offen lds
  s_mov_b32 exec_hi, 0
  s_add_u32 m0, s68, 0
  s_nop 0
  buffer_load_dwordx4 v238, s[24:27], s64 offen lds
  s_mov_b64 exec, -1
  s_lshl_b32 s10, s9, 1
  s_add_u32 s10, s10, 0
  s_and_b32 s10, s10, 15
  s_lshl_b32 s10, s10, 18
  s_add_u32 m0, s63, 0
  s_add_u32 s64, s10, 0
  buffer_load_dwordx4 v236, s[36:39], s64 offen lds
  s_add_u32 m0, s63, 1024
  s_add_u32 s64, s10, 32768
  buffer_load_dwordx4 v236, s[36:39], s64 offen lds
  s_add_u32 m0, s63, 2048
  s_add_u32 s64, s10, 131072
  buffer_load_dwordx4 v236, s[36:39], s64 offen lds
  s_add_u32 m0, s63, 3072
  s_add_u32 s64, s10, 163840
  buffer_load_dwordx4 v236, s[36:39], s64 offen lds
  s_lshr_b32 s64, s2, 3
  s_cmp_ge_u32 s64, 4
  s_cbranch_scc1 Lnct
  s_cmp_lg_u32 s56, 7
  s_cbranch_scc1 Lnct
  s_getpc_b64 s[12:13]
Lpc:
  s_lshl_b32 s64, s64, 13
  v_lshl_add_u32 v5, v0, 7, s64
  v_min_u32 v5, Lend-Lpc, v5
  v_mov_b32 v7, s13
  v_add_co_u32 v6, vcc, s12, v5
  s_nop 1
  v_addc_co_u32 v7, vcc, 0, v7, vcc
  global_load_dword v253, v[6:7], off
Lnct:
  s_lshl_b32 s10, s9, 1
  s_add_u32 s10, s10, 1
  s_and_b32 s10, s10, 15
  s_lshl_b32 s10, s10, 18
  s_add_u32 m0, s63, 33024
  s_add_u32 s64, s10, 0
  buffer_load_dwordx4 v236, s[36:39], s64 offen lds
  s_add_u32 m0, s63, 34048
  s_add_u32 s64, s10, 32768
  buffer_load_dwordx4 v236, s[36:39], s64 offen lds
  s_add_u32 m0, s63, 35072
  s_add_u32 s64, s10, 131072
  buffer_load_dwordx4 v236, s[36:39], s64 offen lds
  s_add_u32 m0, s63, 36096
  s_add_u32 s64, s10, 163840
  buffer_load_dwordx4 v236, s[36:39], s64 offen lds
  v_and_b32 v5, 1, v1
  v_lshl_add_u32 v6, v5, 2, v3
  v_mul_u32_u24 v6, 4128, v6
  v_lshrrev_b32 v7, 1, v1
  v_lshl_add_u32 v6, v7, 11, v6
  v_lshl_add_u32 v6, v4, 3, v6
  s_lshl_b32 s64, s62, 8
  v_add_u32 v232, s64, v6
  v_add_u32 v233, 66048, v232
  v_lshrrev_b32 v6, 1, v2
  v_xor_b32 v6, v6, v1
  v_lshlrev_b32 v6, 4, v6
  v_lshl_add_u32 v6, v2, 7, v6
  s_mul_i32 s64, s61, 6144
  s_add_u32 s64, s64, 132096
  v_add_u32 v234, s64, v6
  v_xor_b32 v235, 64, v234
  v_lshrrev_b32 v6, 3, v0
  v_bfe_u32 v7, v6, 1, 1
  s_and_b32 s64, s56, 1
  s_lshl_b32 s64, s64, 1
  v_add_u32 v7, s64, v7
  v_lshlrev_b32 v7, 1, v7
  v_and_b32 v8, 7, v0
  v_xor_b32 v7, v7, v8
  v_lshlrev_b32 v7, 4, v7
  v_lshl_add_u32 v7, v6, 10, v7
  s_lshl_b32 s64, s57, 19
  s_lshl_b32 s65, s56, 15
  s_add_u32 s64, s64, s65
  v_add_u32 v243, s64, v7
  s_lshl_b32 s69, s56, 12
  v_lshrrev_b32 v6, 1, v3
  v_lshl_add_u32 v6, v5, 1, v6
  v_xor_b32 v6, s62, v6
  v_lshlrev_b32 v6, 5, v6
  v_lshl_add_u32 v6, v4, 3, v6
  v_lshl_add_u32 v7, v1, 5, v3
  v_lshl_add_u32 v244, v7, 7, v6
  v_add_u32 v245, 0x10000, v244
  v_add_u32 v246, 0x20000, v244
  s_lshl_b32 s64, s62, 1
  s_add_u32 s64, s64, s61
  s_mul_i32 s8, s64, 12288
  s_add_u32 s64, s8, 65536
  v_add_u32 v255, s64, v247
  s_mul_i32 s64, s58, 96
  s_mul_i32 s65, s61, 48
  s_add_u32 s64, s64, s65
  s_lshl_b32 s64, s64, 11
  s_lshl_b32 s65, s59, 10
  s_add_u32 s64, s64, s65
  s_lshl_b32 s65, s57, 7
  s_add_u32 s64, s64, s65
  s_lshl_b32 s65, s62, 5
  s_add_u32 s64, s64, s65
  v_lshlrev_b32 v6, 11, v2
  v_lshl_add_u32 v6, v1, 3, v6
  v_add_u32 v252, s64, v6
  s_mov_b32 s70, 0x3e0293ee
  s_mov_b32 s71, 0x05040100
  s_mov_b32 s72, 0x07060302
  s_mov_b32 s74, 0xffff0000
  s_mul_i32 s64, s58, 9363
  s_lshr_b32 s64, s64, 16
  s_mul_i32 s64, s64, 7
  s_sub_u32 s65, s58, s64
  s_add_u32 s64, s65, 0
  s_cmp_ge_u32 s64, 7
  s_cselect_b32 s66, 7, 0
  s_sub_u32 s64, s64, s66
  s_add_u32 s64, s64, s57
  s_add_u32 s64, s64, 1
  s_and_b32 s14, s64, 7
  s_add_u32 s64, s65, 1
  s_cmp_ge_u32 s64, 7
  s_cselect_b32 s66, 7, 0
  s_sub_u32 s64, s64, s66
  s_add_u32 s64, s64, s57
  s_add_u32 s64, s64, 1
  s_and_b32 s15, s64, 7
  s_add_u32 s64, s65, 2
  s_cmp_ge_u32 s64, 7
  s_cselect_b32 s66, 7, 0
  s_sub_u32 s64, s64, s66
  s_add_u32 s64, s64, s57
  s_add_u32 s64, s64, 1
  s_and_b32 s16, s64, 7
  s_add_u32 s64, s65, 3
  s_cmp_ge_u32 s64, 7
  s_cselect_b32 s66, 7, 0
  s_sub_u32 s64, s64, s66
  s_add_u32 s64, s64, s57
  s_add_u32 s64, s64, 1
  s_and_b32 s17, s64, 7
  s_add_u32 s64, s65, 4
  s_cmp_ge_u32 s64, 7
  s_cselect_b32 s66, 7, 0
  s_sub_u32 s64, s64, s66
  s_add_u32 s64, s64, s57
  s_add_u32 s64, s64, 1
  s_and_b32 s18, s64, 7
  s_add_u32 s64, s65, 5
  s_cmp_ge_u32 s64, 7
  s_cselect_b32 s66, 7, 0
  s_sub_u32 s64, s64, s66
  s_add_u32 s64, s64, s57
  s_add_u32 s64, s64, 1
  s_and_b32 s19, s64, 7
  s_add_u32 s64, s65, 6
  s_cmp_ge_u32 s64, 7
  s_cselect_b32 s66, 7, 0
  s_sub_u32 s64, s64, s66
  s_add_u32 s64, s64, s57
  s_add_u32 s64, s64, 1
  s_and_b32 s20, s64, 7
  s_mov_b32 s21, s57
  s_lshl_b32 s64, s60, 6
  s_add_u32 s64, s64, s57
  s_lshl_b32 s64, s64, 3
  s_add_u32 s64, s64, s56
  s_mul_i32 s22, s64, 1536
  s_lshl_b32 s64, s60, 6
  s_add_u32 s64, s64, s56
  s_lshl_b32 s64, s64, 4
  s_add_u32 s23, s64, 33554432
  s_cmp_lg_u32 s56, 0
  s_cbranch_scc1 Lnz
  s_lshl_b32 s64, s57, 7
  s_add_u32 s64, s64, s23
  v_mov_b32 v8, 0
  v_mov_b32 v9, 0
  v_mov_b32 v10, 0
  v_mov_b32 v11, 0
  s_mov_b64 exec, 0xff
  buffer_store_dwordx4 v[8:11], v247, s[48:51], s64 offen sc1
  s_mov_b64 exec, -1
Lnz:
  s_mul_i32 s12, s57, 86016
  s_add_u32 s12, s12, s22
  s_waitcnt vmcnt(4)
  s_barrier
  ds_read_b128 v[192:195], v234 offset:0
  ds_read_b128 v[196:199], v234 offset:2048
  ds_read_b128 v[200:203], v234 offset:4096
  ds_read_b64_tr_b16 v[216:217], v232 offset:0
  ds_read_b64_tr_b16 v[218:219], v232 offset:1024
  ds_read_b64_tr_b16 v[220:221], v232 offset:32
  ds_read_b64_tr_b16 v[222:223], v232 offset:1056
  ds_read_b64_tr_b16 v[224:225], v232 offset:64
  ds_read_b64_tr_b16 v[226:227], v232 offset:1088
  ds_read_b64_tr_b16 v[228:229], v232 offset:96
  ds_read_b64_tr_b16 v[230:231], v232 offset:1120
  s_waitcnt lgkmcnt(6)
  v_mfma_f32_16x16x32_bf16 v[0:3], v[216:219], v[192:195], 0
  s_add_u32 m0, s67, 12288
  s_add_u32 s64, s9, 1
  s_and_b32 s64, s64, 7
  s_lshl_b32 s64, s64, 7
  buffer_load_dwordx4 v237, s[24:27], s64 offen lds
  s_mov_b32 exec_hi, 0
  s_add_u32 m0, s68, 12288
  s_nop 0
  buffer_load_dwordx4 v238, s[24:27], s64 offen lds
  s_mov_b64 exec, -1
  v_mfma_f32_16x16x32_bf16 v[4:7], v[216:219], v[196:199], 0
  s_lshl_b32 s10, s9, 1
  s_add_u32 s10, s10, 2
  s_and_b32 s10, s10, 15
  s_lshl_b32 s10, s10, 18
  s_add_u32 m0, s63, 66048
  s_add_u32 s64, s10, 0
  buffer_load_dwordx4 v236, s[36:39], s64 offen lds
  v_mfma_f32_16x16x32_bf16 v[8:11], v[216:219], v[200:203], 0
  ds_read_b64_tr_b16 v[216:217], v232 offset:128
  ds_read_b64_tr_b16 v[218:219], v232 offset:1152
  s_waitcnt lgkmcnt(6)
  v_mfma_f32_16x16x32_bf16 v[12:15], v[220:223], v[192:195], 0
  s_add_u32 m0, s63, 67072
  s_add_u32 s64, s10, 32768
  buffer_load_dwordx4 v236, s[36:39], s64 offen lds
  v_mfma_f32_16x16x32_bf16 v[16:19], v[220:223], v[196:199], 0
  s_add_u32 m0, s63, 68096
  s_add_u32 s64, s10, 131072
  buffer_load_dwordx4 v236, s[36:39], s64 offen lds
  v_mfma_f32_16x16x32_bf16 v[20:23], v[220:223], v[200:203], 0
  ds_read_b64_tr_b16 v[220:221], v232 offset:160
  ds_read_b64_tr_b16 v[222:223], v232 offset:1184
  s_waitcnt lgkmcnt(6)
  v_mfma_f32_16x16x32_bf16 v[24:27], v[224:227], v[192:195], 0
  s_add_u32 m0, s63, 69120
  s_add_u32 s64, s10, 163840
  buffer_load_dwordx4 v236, s[36:39], s64 offen lds
  v_mfma_f32_16x16x32_bf16 v[28:31], v[224:227], v[196:199], 0
  v_mfma_f32_16x16x32_bf16 v[32:35], v[224:227], v[200:203], 0
  ds_read_b64_tr_b16 v[224:225], v232 offset:192
  ds_read_b64_tr_b16 v[226:227], v232 offset:1216
  s_waitcnt lgkmcnt(6)
  v_mfma_f32_16x16x32_bf16 v[36:39], v[228:231], v[192:195], 0
  v_mfma_f32_16x16x32_bf16 v[40:43], v[228:231], v[196:199], 0
  v_mfma_f32_16x16x32_bf16 v[44:47], v[228:231], v[200:203], 0
  s_waitcnt vmcnt(6)
  s_barrier
  ds_read_b64_tr_b16 v[228:229], v232 offset:224
  ds_read_b64_tr_b16 v[230:231], v232 offset:1248
  s_waitcnt lgkmcnt(6)
  v_mfma_f32_16x16x32_bf16 v[48:51], v[216:219], v[192:195], 0
  s_lshl_b32 s10, s9, 1
  s_add_u32 s10, s10, 3
  s_and_b32 s10, s10, 15
  s_lshl_b32 s10, s10, 18
  s_add_u32 m0, s63, 99072
  s_add_u32 s64, s10, 0
  buffer_load_dwordx4 v236, s[36:39], s64 offen lds
  v_mfma_f32_16x16x32_bf16 v[52:55], v[216:219], v[196:199], 0
  v_mfma_f32_16x16x32_bf16 v[56:59], v[216:219], v[200:203], 0
  ds_read_b64_tr_b16 v[216:217], v232 offset:33024
  ds_read_b64_tr_b16 v[218:219], v232 offset:34048
  ds_read_b128 v[204:207], v235 offset:0
  s_waitcnt lgkmcnt(7)
  v_mfma_f32_16x16x32_bf16 v[60:63], v[220:223], v[192:195], 0
  s_add_u32 m0, s63, 100096
  s_add_u32 s64, s10, 32768
  buffer_load_dwordx4 v236, s[36:39], s64 offen lds
  v_mfma_f32_16x16x32_bf16 v[64:67], v[220:223], v[196:199], 0
  v_mfma_f32_16x16x32_bf16 v[68:71], v[220:223], v[200:203], 0
  ds_read_b64_tr_b16 v[220:221], v232 offset:33056
  ds_read_b64_tr_b16 v[222:223], v232 offset:34080
  ds_read_b128 v[208:211], v235 offset:2048
  s_waitcnt lgkmcnt(8)
  v_mfma_f32_16x16x32_bf16 v[72:75], v[224:227], v[192:195], 0
  s_add_u32 m0, s63, 101120
  s_add_u32 s64, s10, 131072
  buffer_load_dwordx4 v236, s[36:39], s64 offen lds
  v_mfma_f32_16x16x32_bf16 v[76:79], v[224:227], v[196:199], 0
  v_mfma_f32_16x16x32_bf16 v[80:83], v[224:227], v[200:203], 0
  ds_read_b64_tr_b16 v[224:225], v232 offset:33088
  ds_read_b64_tr_b16 v[226:227], v232 offset:34112
  ds_read_b128 v[212:215], v235 offset:4096
  s_waitcnt lgkmcnt(9)
  v_mfma_f32_16x16x32_bf16 v[84:87], v[228:231], v[192:195], 0
  s_add_u32 m0, s63, 102144
  s_add_u32 s64, s10, 163840
  buffer_load_dwordx4 v236, s[36:39], s64 offen lds
  v_mfma_f32_16x16x32_bf16 v[88:91], v[228:231], v[196:199], 0
  v_mfma_f32_16x16x32_bf16 v[92:95], v[228:231], v[200:203], 0
  ds_read_b64_tr_b16 v[228:229], v232 offset:33120
  ds_read_b64_tr_b16 v[230:231], v232 offset:34144
  s_waitcnt lgkmcnt(2)
  v_mfma_f32_16x16x32_bf16 v[0:3], v[216:219], v[204:207], v[0:3]
  v_mfma_f32_16x16x32_bf16 v[4:7], v[216:219], v[208:211], v[4:7]
  v_mfma_f32_16x16x32_bf16 v[8:11], v[216:219], v[212:215], v[8:11]
  ds_read_b64_tr_b16 v[216:217], v232 offset:33152
  ds_read_b64_tr_b16 v[218:219], v232 offset:34176
  v_mfma_f32_16x16x32_bf16 v[12:15], v[220:223], v[204:207], v[12:15]
  v_mfma_f32_16x16x32_bf16 v[16:19], v[220:223], v[208:211], v[16:19]
  v_mfma_f32_16x16x32_bf16 v[20:23], v[220:223], v[212:215], v[20:23]
  ds_read_b64_tr_b16 v[220:221], v232 offset:33184
  ds_read_b64_tr_b16 v[222:223], v232 offset:34208
  v_mfma_f32_16x16x32_bf16 v[24:27], v[224:227], v[204:207], v[24:27]
  v_mfma_f32_16x16x32_bf16 v[28:31], v[224:227], v[208:211], v[28:31]
  v_mfma_f32_16x16x32_bf16 v[32:35], v[224:227], v[212:215], v[32:35]
  ds_read_b64_tr_b16 v[224:225], v232 offset:33216
  ds_read_b64_tr_b16 v[226:227], v232 offset:34240
  s_waitcnt lgkmcnt(6)
  v_mfma_f32_16x16x32_bf16 v[36:39], v[228:231], v[204:207], v[36:39]
  v_mfma_f32_16x16x32_bf16 v[40:43], v[228:231], v[208:211], v[40:43]
  v_mfma_f32_16x16x32_bf16 v[44:47], v[228:231], v[212:215], v[44:47]
  s_waitcnt vmcnt(4)
  s_barrier
  ds_read_b64_tr_b16 v[228:229], v232 offset:33248
  ds_read_b64_tr_b16 v[230:231], v232 offset:34272
  s_waitcnt lgkmcnt(6)
  v_mfma_f32_16x16x32_bf16 v[48:51], v[216:219], v[204:207], v[48:51]
  s_add_u32 m0, s67, 0
  s_add_u32 s64, s9, 2
  s_and_b32 s64, s64, 7
  s_lshl_b32 s64, s64, 7
  buffer_load_dwordx4 v237, s[24:27], s64 offen lds
  s_mov_b32 exec_hi, 0
  s_add_u32 m0, s68, 0
  s_nop 0
  buffer_load_dwordx4 v238, s[24:27], s64 offen lds
  s_mov_b64 exec, -1
  v_mfma_f32_16x16x32_bf16 v[52:55], v[216:219], v[208:211], v[52:55]
  v_mfma_f32_16x16x32_bf16 v[56:59], v[216:219], v[212:215], v[56:59]
  ds_read_b64_tr_b16 v[216:217], v233 offset:0
  ds_read_b64_tr_b16 v[218:219], v233 offset:1024
  ds_read_b128 v[192:195], v234 offset:12288
  s_waitcnt lgkmcnt(7)
  v_mfma_f32_16x16x32_bf16 v[60:63], v[220:223], v[204:207], v[60:63]
  s_lshl_b32 s10, s9, 1
  s_add_u32 s10, s10, 4
  s_and_b32 s10, s10, 15
  s_lshl_b32 s10, s10, 18
  s_add_u32 m0, s63, 0
  s_add_u32 s64, s10, 0
  buffer_load_dwordx4 v236, s[36:39], s64 offen lds
  v_mfma_f32_16x16x32_bf16 v[64:67], v[220:223], v[208:211], v[64:67]
  v_mfma_f32_16x16x32_bf16 v[68:71], v[220:223], v[212:215], v[68:71]
  ds_read_b64_tr_b16 v[220:221], v233 offset:32
  ds_read_b64_tr_b16 v[222:223], v233 offset:1056
  ds_read_b128 v[196:199], v234 offset:14336
  s_waitcnt lgkmcnt(8)
  v_mfma_f32_16x16x32_bf16 v[72:75], v[224:227], v[204:207], v[72:75]
  s_add_u32 m0, s63, 1024
  s_add_u32 s64, s10, 32768
  buffer_load_dwordx4 v236, s[36:39], s64 offen lds
  v_mfma_f32_16x16x32_bf16 v[76:79], v[224:227], v[208:211], v[76:79]
  v_mfma_f32_16x16x32_bf16 v[80:83], v[224:227], v[212:215], v[80:83]
  ds_read_b64_tr_b16 v[224:225], v233 offset:64
  ds_read_b64_tr_b16 v[226:227], v233 offset:1088
  ds_read_b128 v[200:203], v234 offset:16384
  s_waitcnt lgkmcnt(9)
  v_mfma_f32_16x16x32_bf16 v[84:87], v[228:231], v[204:207], v[84:87]
  s_add_u32 m0, s63, 2048
  s_add_u32 s64, s10, 131072
  buffer_load_dwordx4 v236, s[36:39], s64 offen lds
  v_mfma_f32_16x16x32_bf16 v[88:91], v[228:231], v[208:211], v[88:91]
  v_mfma_f32_16x16x32_bf16 v[92:95], v[228:231], v[212:215], v[92:95]
  ds_read_b64_tr_b16 v[228:229], v233 offset:96
  ds_read_b64_tr_b16 v[230:231], v233 offset:1120
  s_waitcnt lgkmcnt(2)
  v_mfma_f32_16x16x32_bf16 v[0:3], v[216:219], v[192:195], v[0:3]
  s_add_u32 m0, s63, 3072
  s_add_u32 s64, s10, 163840
  buffer_load_dwordx4 v236, s[36:39], s64 offen lds
  v_mfma_f32_16x16x32_bf16 v[4:7], v[216:219], v[196:199], v[4:7]
  v_mfma_f32_16x16x32_bf16 v[8:11], v[216:219], v[200:203], v[8:11]
  ds_read_b64_tr_b16 v[216:217], v233 offset:128
  ds_read_b64_tr_b16 v[218:219], v233 offset:1152
  v_mfma_f32_16x16x32_bf16 v[12:15], v[220:223], v[192:195], v[12:15]
  s_cmp_lg_u32 s75, 0
  s_cbranch_scc1 Lkv0_0
  buffer_load_dwordx4 v[96:99], v239, s[28:31], 0 offen offset:0 nt
  buffer_load_dwordx4 v[100:103], v239, s[28:31], 0 offen offset:2048 nt
  buffer_load_dwordx4 v[104:107], v239, s[28:31], s6 offen offset:0 nt
  buffer_load_dwordx4 v[108:111], v239, s[28:31], s6 offen offset:2048 nt
  buffer_load_dwordx4 v[112:115], v239, s[28:31], 0 offen offset:1024 nt
  buffer_load_dwordx4 v[116:119], v239, s[28:31], 0 offen offset:3072 nt
Lkv0_0:
  v_mfma_f32_16x16x32_bf16 v[16:19], v[220:223], v[196:199], v[16:19]
  v_mfma_f32_16x16x32_bf16 v[20:23], v[220:223], v[200:203], v[20:23]
  ds_read_b64_tr_b16 v[220:221], v233 offset:160
  ds_read_b64_tr_b16 v[222:223], v233 offset:1184
  v_mfma_f32_16x16x32_bf16 v[24:27], v[224:227], v[192:195], v[24:27]
  v_mfma_f32_16x16x32_bf16 v[28:31], v[224:227], v[196:199], v[28:31]
  v_mfma_f32_16x16x32_bf16 v[32:35], v[224:227], v[200:203], v[32:35]
  ds_read_b64_tr_b16 v[224:225], v233 offset:192
  ds_read_b64_tr_b16 v[226:227], v233 offset:1216
  s_waitcnt lgkmcnt(6)
  v_mfma_f32_16x16x32_bf16 v[36:39], v[228:231], v[192:195], v[36:39]
  v_mfma_f32_16x16x32_bf16 v[40:43], v[228:231], v[196:199], v[40:43]
  v_mfma_f32_16x16x32_bf16 v[44:47], v[228:231], v[200:203], v[44:47]
  s_cmp_lg_u32 s75, 0
  s_cbranch_scc1 Lw1_0
  s_waitcnt vmcnt(12)
  s_branch Lw1
Lw1_0:
  s_waitcnt vmcnt(6)
Lw1:
  s_barrier
  ds_read_b64_tr_b16 v[228:229], v233 offset:224
  ds_read_b64_tr_b16 v[230:231], v233 offset:1248
  s_waitcnt lgkmcnt(6)
  v_mfma_f32_16x16x32_bf16 v[48:51], v[216:219], v[192:195], v[48:51]
  s_lshl_b32 s10, s9, 1
  s_add_u32 s10, s10, 5
  s_and_b32 s10, s10, 15
  s_lshl_b32 s10, s10, 18
  s_add_u32 m0, s63, 33024
  s_add_u32 s64, s10, 0
  buffer_load_dwordx4 v236, s[36:39], s64 offen lds
  v_mfma_f32_16x16x32_bf16 v[52:55], v[216:219], v[196:199], v[52:55]
  v_mfma_f32_16x16x32_bf16 v[56:59], v[216:219], v[200:203], v[56:59]
  ds_read_b64_tr_b16 v[216:217], v233 offset:33024
  ds_read_b64_tr_b16 v[218:219], v233 offset:34048
  ds_read_b128 v[204:207], v235 offset:12288
  s_waitcnt lgkmcnt(7)
  v_mfma_f32_16x16x32_bf16 v[60:63], v[220:223], v[192:195], v[60:63]
  s_add_u32 m0, s63, 34048
  s_add_u32 s64, s10, 32768
  buffer_load_dwordx4 v236, s[36:39], s64 offen lds
  v_mfma_f32_16x16x32_bf16 v[64:67], v[220:223], v[196:199], v[64:67]
  v_mfma_f32_16x16x32_bf16 v[68:71], v[220:223], v[200:203], v[68:71]
  ds_read_b64_tr_b16 v[220:221], v233 offset:33056
  ds_read_b64_tr_b16 v[222:223], v233 offset:34080
  ds_read_b128 v[208:211], v235 offset:14336
  s_waitcnt lgkmcnt(8)
  v_mfma_f32_16x16x32_bf16 v[72:75], v[224:227], v[192:195], v[72:75]
  s_add_u32 m0, s63, 35072
  s_add_u32 s64, s10, 131072
  buffer_load_dwordx4 v236, s[36:39], s64 offen lds
  v_mfma_f32_16x16x32_bf16 v[76:79], v[224:227], v[196:199], v[76:79]
  v_mfma_f32_16x16x32_bf16 v[80:83], v[224:227], v[200:203], v[80:83]
  ds_read_b64_tr_b16 v[224:225], v233 offset:33088
  ds_read_b64_tr_b16 v[226:227], v233 offset:34112
  ds_read_b128 v[212:215], v235 offset:16384
  s_waitcnt lgkmcnt(9)
  v_mfma_f32_16x16x32_bf16 v[84:87], v[228:231], v[192:195], v[84:87]
  s_add_u32 m0, s63, 36096
  s_add_u32 s64, s10, 163840
  buffer_load_dwordx4 v236, s[36:39], s64 offen lds
  v_mfma_f32_16x16x32_bf16 v[88:91], v[228:231], v[196:199], v[88:91]
  v_mfma_f32_16x16x32_bf16 v[92:95], v[228:231], v[200:203], v[92:95]
  ds_read_b64_tr_b16 v[228:229], v233 offset:33120
  ds_read_b64_tr_b16 v[230:231], v233 offset:34144
  s_waitcnt lgkmcnt(2)
  v_mfma_f32_16x16x32_bf16 v[0:3], v[216:219], v[204:207], v[0:3]
  s_cmp_lg_u32 s75, 1
  s_cbranch_scc1 Lkv1_0
  buffer_load_dwordx4 v[96:99], v239, s[28:31], 0 offen offset:0 nt
  buffer_load_dwordx4 v[100:103], v239, s[28:31], 0 offen offset:2048 nt
  buffer_load_dwordx4 v[104:107], v239, s[28:31], s6 offen offset:0 nt
  buffer_load_dwordx4 v[108:111], v239, s[28:31], s6 offen offset:2048 nt
  buffer_load_dwordx4 v[112:115], v239, s[28:31], 0 offen offset:1024 nt
  buffer_load_dwordx4 v[116:119], v239, s[28:31], 0 offen offset:3072 nt
Lkv1_0:
  v_mfma_f32_16x16x32_bf16 v[4:7], v[216:219], v[208:211], v[4:7]
  v_mfma_f32_16x16x32_bf16 v[8:11], v[216:219], v[212:215], v[8:11]
  ds_read_b64_tr_b16 v[216:217], v233 offset:33152
  ds_read_b64_tr_b16 v[218:219], v233 offset:34176
  v_mfma_f32_16x16x32_bf16 v[12:15], v[220:223], v[204:207], v[12:15]
  v_mfma_f32_16x16x32_bf16 v[16:19], v[220:223], v[208:211], v[16:19]
  v_mfma_f32_16x16x32_bf16 v[20:23], v[220:223], v[212:215], v[20:23]
  ds_read_b64_tr_b16 v[220:221], v233 offset:33184
  ds_read_b64_tr_b16 v[222:223], v233 offset:34208
  v_mfma_f32_16x16x32_bf16 v[24:27], v[224:227], v[204:207], v[24:27]
  v_mfma_f32_16x16x32_bf16 v[28:31], v[224:227], v[208:211], v[28:31]
  v_mfma_f32_16x16x32_bf16 v[32:35], v[224:227], v[212:215], v[32:35]
  ds_read_b64_tr_b16 v[224:225], v233 offset:33216
  ds_read_b64_tr_b16 v[226:227], v233 offset:34240
  s_waitcnt lgkmcnt(6)
  v_mfma_f32_16x16x32_bf16 v[36:39], v[228:231], v[204:207], v[36:39]
  v_mfma_f32_16x16x32_bf16 v[40:43], v[228:231], v[208:211], v[40:43]
  v_mfma_f32_16x16x32_bf16 v[44:47], v[228:231], v[212:215], v[44:47]
  s_cmp_lg_u32 s75, 0
  s_cbranch_scc1 Lw2_0
  s_waitcnt vmcnt(10)
  s_branch Lw2
Lw2_0:
  s_cmp_lg_u32 s75, 1
  s_cbranch_scc1 Lw2_1
  s_waitcnt vmcnt(10)
  s_branch Lw2
Lw2_1:
  s_waitcnt vmcnt(4)
Lw2:
  s_barrier
  ds_read_b64_tr_b16 v[228:229], v233 offset:33248
  ds_read_b64_tr_b16 v[230:231], v233 offset:34272
  s_waitcnt lgkmcnt(6)
  v_mfma_f32_16x16x32_bf16 v[48:51], v[216:219], v[204:207], v[48:51]
  s_add_u32 m0, s67, 12288
  s_add_u32 s64, s9, 3
  s_and_b32 s64, s64, 7
  s_lshl_b32 s64, s64, 7
  buffer_load_dwordx4 v237, s[24:27], s64 offen lds
  s_mov_b32 exec_hi, 0
  s_add_u32 m0, s68, 12288
  s_nop 0
  buffer_load_dwordx4 v238, s[24:27], s64 offen lds
  s_mov_b64 exec, -1
  v_mfma_f32_16x16x32_bf16 v[52:55], v[216:219], v[208:211], v[52:55]
  v_mfma_f32_16x16x32_bf16 v[56:59], v[216:219], v[212:215], v[56:59]
  ds_read_b64_tr_b16 v[216:217], v232 offset:0
  ds_read_b64_tr_b16 v[218:219], v232 offset:1024
  ds_read_b128 v[192:195], v234 offset:0
  s_waitcnt lgkmcnt(7)
  v_mfma_f32_16x16x32_bf16 v[60:63], v[220:223], v[204:207], v[60:63]
  s_lshl_b32 s10, s9, 1
  s_add_u32 s10, s10, 6
  s_and_b32 s10, s10, 15
  s_lshl_b32 s10, s10, 18
  s_add_u32 m0, s63, 66048
  s_add_u32 s64, s10, 0
  buffer_load_dwordx4 v236, s[36:39], s64 offen lds
  v_mfma_f32_16x16x32_bf16 v[64:67], v[220:223], v[208:211], v[64:67]
  v_mfma_f32_16x16x32_bf16 v[68:71], v[220:223], v[212:215], v[68:71]
  ds_read_b64_tr_b16 v[220:221], v232 offset:32
  ds_read_b64_tr_b16 v[222:223], v232 offset:1056
  ds_read_b128 v[196:199], v234 offset:2048
  s_waitcnt lgkmcnt(8)
  v_mfma_f32_16x16x32_bf16 v[72:75], v[224:227], v[204:207], v[72:75]
  s_add_u32 m0, s63, 67072
  s_add_u32 s64, s10, 32768
  buffer_load_dwordx4 v236, s[36:39], s64 offen lds
  v_mfma_f32_16x16x32_bf16 v[76:79], v[224:227], v[208:211], v[76:79]
  v_mfma_f32_16x16x32_bf16 v[80:83], v[224:227], v[212:215], v[80:83]
  ds_read_b64_tr_b16 v[224:225], v232 offset:64
  ds_read_b64_tr_b16 v[226:227], v232 offset:1088
  ds_read_b128 v[200:203], v234 offset:4096
  s_waitcnt lgkmcnt(9)
  v_mfma_f32_16x16x32_bf16 v[84:87], v[228:231], v[204:207], v[84:87]
  s_add_u32 m0, s63, 68096
  s_add_u32 s64, s10, 131072
  buffer_load_dwordx4 v236, s[36:39], s64 offen lds
  v_mfma_f32_16x16x32_bf16 v[88:91], v[228:231], v[208:211], v[88:91]
  v_mfma_f32_16x16x32_bf16 v[92:95], v[228:231], v[212:215], v[92:95]
  ds_read_b64_tr_b16 v[228:229], v232 offset:96
  ds_read_b64_tr_b16 v[230:231], v232 offset:1120
  s_waitcnt lgkmcnt(2)
  v_mfma_f32_16x16x32_bf16 v[0:3], v[216:219], v[192:195], v[0:3]
  s_add_u32 m0, s63, 69120
  s_add_u32 s64, s10, 163840
  buffer_load_dwordx4 v236, s[36:39], s64 offen lds
  v_mfma_f32_16x16x32_bf16 v[4:7], v[216:219], v[196:199], v[4:7]
  v_mfma_f32_16x16x32_bf16 v[8:11], v[216:219], v[200:203], v[8:11]
  ds_read_b64_tr_b16 v[216:217], v232 offset:128
  ds_read_b64_tr_b16 v[218:219], v232 offset:1152
  v_mfma_f32_16x16x32_bf16 v[12:15], v[220:223], v[192:195], v[12:15]
  s_cmp_lg_u32 s75, 2
  s_cbranch_scc1 Lkv2_0
  buffer_load_dwordx4 v[96:99], v239, s[28:31], 0 offen offset:0 nt
  buffer_load_dwordx4 v[100:103], v239, s[28:31], 0 offen offset:2048 nt
  buffer_load_dwordx4 v[104:107], v239, s[28:31], s6 offen offset:0 nt
  buffer_load_dwordx4 v[108:111], v239, s[28:31], s6 offen offset:2048 nt
  buffer_load_dwordx4 v[112:115], v239, s[28:31], 0 offen offset:1024 nt
  buffer_load_dwordx4 v[116:119], v239, s[28:31], 0 offen offset:3072 nt
Lkv2_0:
  v_mfma_f32_16x16x32_bf16 v[16:19], v[220:223], v[196:199], v[16:19]
  v_mfma_f32_16x16x32_bf16 v[20:23], v[220:223], v[200:203], v[20:23]
  ds_read_b64_tr_b16 v[220:221], v232 offset:160
  ds_read_b64_tr_b16 v[222:223], v232 offset:1184
  v_mfma_f32_16x16x32_bf16 v[24:27], v[224:227], v[192:195], v[24:27]
  v_mfma_f32_16x16x32_bf16 v[28:31], v[224:227], v[196:199], v[28:31]
  v_mfma_f32_16x16x32_bf16 v[32:35], v[224:227], v[200:203], v[32:35]
  ds_read_b64_tr_b16 v[224:225], v232 offset:192
  ds_read_b64_tr_b16 v[226:227], v232 offset:1216
  s_waitcnt lgkmcnt(6)
  v_mfma_f32_16x16x32_bf16 v[36:39], v[228:231], v[192:195], v[36:39]
  v_mfma_f32_16x16x32_bf16 v[40:43], v[228:231], v[196:199], v[40:43]
  v_mfma_f32_16x16x32_bf16 v[44:47], v[228:231], v[200:203], v[44:47]
  s_cmp_lg_u32 s75, 1
  s_cbranch_scc1 Lw3_1
  s_waitcnt vmcnt(12)
  s_branch Lw3
Lw3_1:
  s_cmp_lg_u32 s75, 2
  s_cbranch_scc1 Lw3_2
  s_waitcnt vmcnt(12)
  s_branch Lw3
Lw3_2:
  s_waitcnt vmcnt(6)
Lw3:
  s_barrier
  ds_read_b64_tr_b16 v[228:229], v232 offset:224
  ds_read_b64_tr_b16 v[230:231], v232 offset:1248
  s_waitcnt lgkmcnt(6)
  v_mfma_f32_16x16x32_bf16 v[48:51], v[216:219], v[192:195], v[48:51]
  s_lshl_b32 s10, s9, 1
  s_add_u32 s10, s10, 7
  s_and_b32 s10, s10, 15
  s_lshl_b32 s10, s10, 18
  s_add_u32 m0, s63, 99072
  s_add_u32 s64, s10, 0
  buffer_load_dwordx4 v236, s[36:39], s64 offen lds
  v_mfma_f32_16x16x32_bf16 v[52:55], v[216:219], v[196:199], v[52:55]
  v_mfma_f32_16x16x32_bf16 v[56:59], v[216:219], v[200:203], v[56:59]
  ds_read_b64_tr_b16 v[216:217], v232 offset:33024
  ds_read_b64_tr_b16 v[218:219], v232 offset:34048
  ds_read_b128 v[204:207], v235 offset:0
  s_waitcnt lgkmcnt(7)
  v_mfma_f32_16x16x32_bf16 v[60:63], v[220:223], v[192:195], v[60:63]
  s_add_u32 m0, s63, 100096
  s_add_u32 s64, s10, 32768
  buffer_load_dwordx4 v236, s[36:39], s64 offen lds
  v_mfma_f32_16x16x32_bf16 v[64:67], v[220:223], v[196:199], v[64:67]
  v_mfma_f32_16x16x32_bf16 v[68:71], v[220:223], v[200:203], v[68:71]
  ds_read_b64_tr_b16 v[220:221], v232 offset:33056
  ds_read_b64_tr_b16 v[222:223], v232 offset:34080
  ds_read_b128 v[208:211], v235 offset:2048
  s_waitcnt lgkmcnt(8)
  v_mfma_f32_16x16x32_bf16 v[72:75], v[224:227], v[192:195], v[72:75]
  s_add_u32 m0, s63, 101120
  s_add_u32 s64, s10, 131072
  buffer_load_dwordx4 v236, s[36:39], s64 offen lds
  v_mfma_f32_16x16x32_bf16 v[76:79], v[224:227], v[196:199], v[76:79]
  v_mfma_f32_16x16x32_bf16 v[80:83], v[224:227], v[200:203], v[80:83]
  ds_read_b64_tr_b16 v[224:225], v232 offset:33088
  ds_read_b64_tr_b16 v[226:227], v232 offset:34112
  ds_read_b128 v[212:215], v235 offset:4096
  s_waitcnt lgkmcnt(9)
  v_mfma_f32_16x16x32_bf16 v[84:87], v[228:231], v[192:195], v[84:87]
  s_add_u32 m0, s63, 102144
  s_add_u32 s64, s10, 163840
  buffer_load_dwordx4 v236, s[36:39], s64 offen lds
  v_mfma_f32_16x16x32_bf16 v[88:91], v[228:231], v[196:199], v[88:91]
  v_mfma_f32_16x16x32_bf16 v[92:95], v[228:231], v[200:203], v[92:95]
  ds_read_b64_tr_b16 v[228:229], v232 offset:33120
  ds_read_b64_tr_b16 v[230:231], v232 offset:34144
  s_waitcnt lgkmcnt(2)
  v_mfma_f32_16x16x32_bf16 v[0:3], v[216:219], v[204:207], v[0:3]
  s_cmp_lg_u32 s75, 3
  s_cbranch_scc1 Lkv3_0
  buffer_load_dwordx4 v[96:99], v239, s[28:31], 0 offen offset:0 nt
  buffer_load_dwordx4 v[100:103], v239, s[28:31], 0 offen offset:2048 nt
  buffer_load_dwordx4 v[104:107], v239, s[28:31], s6 offen offset:0 nt
  buffer_load_dwordx4 v[108:111], v239, s[28:31], s6 offen offset:2048 nt
  buffer_load_dwordx4 v[112:115], v239, s[28:31], 0 offen offset:1024 nt
  buffer_load_dwordx4 v[116:119], v239, s[28:31], 0 offen offset:3072 nt
Lkv3_0:
  v_mfma_f32_16x16x32_bf16 v[4:7], v[216:219], v[208:211], v[4:7]
  v_mfma_f32_16x16x32_bf16 v[8:11], v[216:219], v[212:215], v[8:11]
  ds_read_b64_tr_b16 v[216:217], v232 offset:33152
  ds_read_b64_tr_b16 v[218:219], v232 offset:34176
  v_mfma_f32_16x16x32_bf16 v[12:15], v[220:223], v[204:207], v[12:15]
  v_mfma_f32_16x16x32_bf16 v[16:19], v[220:223], v[208:211], v[16:19]
  v_mfma_f32_16x16x32_bf16 v[20:23], v[220:223], v[212:215], v[20:23]
  ds_read_b64_tr_b16 v[220:221], v232 offset:33184
  ds_read_b64_tr_b16 v[222:223], v232 offset:34208
  v_mfma_f32_16x16x32_bf16 v[24:27], v[224:227], v[204:207], v[24:27]
  v_mfma_f32_16x16x32_bf16 v[28:31], v[224:227], v[208:211], v[28:31]
  v_mfma_f32_16x16x32_bf16 v[32:35], v[224:227], v[212:215], v[32:35]
  ds_read_b64_tr_b16 v[224:225], v232 offset:33216
  ds_read_b64_tr_b16 v[226:227], v232 offset:34240
  s_waitcnt lgkmcnt(6)
  v_mfma_f32_16x16x32_bf16 v[36:39], v[228:231], v[204:207], v[36:39]
  v_mfma_f32_16x16x32_bf16 v[40:43], v[228:231], v[208:211], v[40:43]
  v_mfma_f32_16x16x32_bf16 v[44:47], v[228:231], v[212:215], v[44:47]
  s_cmp_lg_u32 s75, 2
  s_cbranch_scc1 Lw4_2
  s_waitcnt vmcnt(10)
  s_branch Lw4
Lw4_2:
  s_cmp_lg_u32 s75, 3
  s_cbranch_scc1 Lw4_3
  s_waitcnt vmcnt(10)
  s_branch Lw4
Lw4_3:
  s_waitcnt vmcnt(4)
Lw4:
  s_barrier
  ds_read_b64_tr_b16 v[228:229], v232 offset:33248
  ds_read_b64_tr_b16 v[230:231], v232 offset:34272
  s_waitcnt lgkmcnt(6)
  v_mfma_f32_16x16x32_bf16 v[48:51], v[216:219], v[204:207], v[48:51]
  s_add_u32 m0, s67, 0
  s_add_u32 s64, s9, 4
  s_and_b32 s64, s64, 7
  s_lshl_b32 s64, s64, 7
  buffer_load_dwordx4 v237, s[24:27], s64 offen lds
  s_mov_b32 exec_hi, 0
  s_add_u32 m0, s68, 0
  s_nop 0
  buffer_load_dwordx4 v238, s[24:27], s64 offen lds
  s_mov_b64 exec, -1
  v_mfma_f32_16x16x32_bf16 v[52:55], v[216:219], v[208:211], v[52:55]
  v_mfma_f32_16x16x32_bf16 v[56:59], v[216:219], v[212:215], v[56:59]
  ds_read_b64_tr_b16 v[216:217], v233 offset:0
  ds_read_b64_tr_b16 v[218:219], v233 offset:1024
  ds_read_b128 v[192:195], v234 offset:12288
  s_waitcnt lgkmcnt(7)
  v_mfma_f32_16x16x32_bf16 v[60:63], v[220:223], v[204:207], v[60:63]
  s_lshl_b32 s10, s9, 1
  s_add_u32 s10, s10, 8
  s_and_b32 s10, s10, 15
  s_lshl_b32 s10, s10, 18
  s_add_u32 m0, s63, 0
  s_add_u32 s64, s10, 0
  buffer_load_dwordx4 v236, s[36:39], s64 offen lds
  v_mfma_f32_16x16x32_bf16 v[64:67], v[220:223], v[208:211], v[64:67]
  v_mfma_f32_16x16x32_bf16 v[68:71], v[220:223], v[212:215], v[68:71]
  ds_read_b64_tr_b16 v[220:221], v233 offset:32
  ds_read_b64_tr_b16 v[222:223], v233 offset:1056
  ds_read_b128 v[196:199], v234 offset:14336
  s_waitcnt lgkmcnt(8)
  v_mfma_f32_16x16x32_bf16 v[72:75], v[224:227], v[204:207], v[72:75]
  s_add_u32 m0, s63, 1024
  s_add_u32 s64, s10, 32768
  buffer_load_dwordx4 v236, s[36:39], s64 offen lds
  v_mfma_f32_16x16x32_bf16 v[76:79], v[224:227], v[208:211], v[76:79]
  v_mfma_f32_16x16x32_bf16 v[80:83], v[224:227], v[212:215], v[80:83]
  ds_read_b64_tr_b16 v[224:225], v233 offset:64
  ds_read_b64_tr_b16 v[226:227], v233 offset:1088
  ds_read_b128 v[200:203], v234 offset:16384
  s_waitcnt lgkmcnt(9)
  v_mfma_f32_16x16x32_bf16 v[84:87], v[228:231], v[204:207], v[84:87]
  s_add_u32 m0, s63, 2048
  s_add_u32 s64, s10, 131072
  buffer_load_dwordx4 v236, s[36:39], s64 offen lds
  v_mfma_f32_16x16x32_bf16 v[88:91], v[228:231], v[208:211], v[88:91]
  v_mfma_f32_16x16x32_bf16 v[92:95], v[228:231], v[212:215], v[92:95]
  ds_read_b64_tr_b16 v[228:229], v233 offset:96
  ds_read_b64_tr_b16 v[230:231], v233 offset:1120
  s_waitcnt lgkmcnt(2)
  v_mfma_f32_16x16x32_bf16 v[0:3], v[216:219], v[192:195], v[0:3]
  s_add_u32 m0, s63, 3072
  s_add_u32 s64, s10, 163840
  buffer_load_dwordx4 v236, s[36:39], s64 offen lds
  v_mfma_f32_16x16x32_bf16 v[4:7], v[216:219], v[196:199], v[4:7]
  v_mfma_f32_16x16x32_bf16 v[8:11], v[216:219], v[200:203], v[8:11]
  ds_read_b64_tr_b16 v[216:217], v233 offset:128
  ds_read_b64_tr_b16 v[218:219], v233 offset:1152
  v_mfma_f32_16x16x32_bf16 v[12:15], v[220:223], v[192:195], v[12:15]
  s_cmp_lg_u32 s75, 0
  s_cbranch_scc1 Lkv0_6
  buffer_load_dwordx4 v[120:123], v239, s[28:31], s6 offen offset:1024 nt
  buffer_load_dwordx4 v[124:127], v239, s[28:31], s6 offen offset:3072 nt
  buffer_load_dwordx4 v[128:131], v240, s[28:31], 0 offen offset:0 nt
  buffer_load_dwordx4 v[132:135], v240, s[28:31], 0 offen offset:1024 nt
  buffer_load_dwordx4 v[136:139], v240, s[28:31], s7 offen offset:0 nt
  buffer_load_dwordx4 v[140:143], v240, s[28:31], s7 offen offset:1024 nt
Lkv0_6:
  v_mfma_f32_16x16x32_bf16 v[16:19], v[220:223], v[196:199], v[16:19]
  v_mfma_f32_16x16x32_bf16 v[20:23], v[220:223], v[200:203], v[20:23]
  ds_read_b64_tr_b16 v[220:221], v233 offset:160
  ds_read_b64_tr_b16 v[222:223], v233 offset:1184
  v_mfma_f32_16x16x32_bf16 v[24:27], v[224:227], v[192:195], v[24:27]
  v_mfma_f32_16x16x32_bf16 v[28:31], v[224:227], v[196:199], v[28:31]
  v_mfma_f32_16x16x32_bf16 v[32:35], v[224:227], v[200:203], v[32:35]
  ds_read_b64_tr_b16 v[224:225], v233 offset:192
  ds_read_b64_tr_b16 v[226:227], v233 offset:1216
  s_waitcnt lgkmcnt(6)
  v_mfma_f32_16x16x32_bf16 v[36:39], v[228:231], v[192:195], v[36:39]
  v_mfma_f32_16x16x32_bf16 v[40:43], v[228:231], v[196:199], v[40:43]
  v_mfma_f32_16x16x32_bf16 v[44:47], v[228:231], v[200:203], v[44:47]
  s_cmp_lg_u32 s75, 0
  s_cbranch_scc1 Lw5_0
  s_waitcnt vmcnt(12)
  s_branch Lw5
Lw5_0:
  s_cmp_lg_u32 s75, 3
  s_cbranch_scc1 Lw5_3
  s_waitcnt vmcnt(12)
  s_branch Lw5
Lw5_3:
  s_waitcnt vmcnt(6)
Lw5:
  s_barrier
  ds_read_b64_tr_b16 v[228:229], v233 offset:224
  ds_read_b64_tr_b16 v[230:231], v233 offset:1248
  s_waitcnt lgkmcnt(6)
  v_mfma_f32_16x16x32_bf16 v[48:51], v[216:219], v[192:195], v[48:51]
  s_lshl_b32 s10, s9, 1
  s_add_u32 s10, s10, 9
  s_and_b32 s10, s10, 15
  s_lshl_b32 s10, s10, 18
  s_add_u32 m0, s63, 33024
  s_add_u32 s64, s10, 0
  buffer_load_dwordx4 v236, s[36:39], s64 offen lds
  v_mfma_f32_16x16x32_bf16 v[52:55], v[216:219], v[196:199], v[52:55]
  v_mfma_f32_16x16x32_bf16 v[56:59], v[216:219], v[200:203], v[56:59]
  ds_read_b64_tr_b16 v[216:217], v233 offset:33024
  ds_read_b64_tr_b16 v[218:219], v233 offset:34048
  ds_read_b128 v[204:207], v235 offset:12288
  s_waitcnt lgkmcnt(7)
  v_mfma_f32_16x16x32_bf16 v[60:63], v[220:223], v[192:195], v[60:63]
  s_add_u32 m0, s63, 34048
  s_add_u32 s64, s10, 32768
  buffer_load_dwordx4 v236, s[36:39], s64 offen lds
  v_mfma_f32_16x16x32_bf16 v[64:67], v[220:223], v[196:199], v[64:67]
  v_mfma_f32_16x16x32_bf16 v[68:71], v[220:223], v[200:203], v[68:71]
  ds_read_b64_tr_b16 v[220:221], v233 offset:33056
  ds_read_b64_tr_b16 v[222:223], v233 offset:34080
  ds_read_b128 v[208:211], v235 offset:14336
  s_waitcnt lgkmcnt(8)
  v_mfma_f32_16x16x32_bf16 v[72:75], v[224:227], v[192:195], v[72:75]
  s_add_u32 m0, s63, 35072
  s_add_u32 s64, s10, 131072
  buffer_load_dwordx4 v236, s[36:39], s64 offen lds
  v_mfma_f32_16x16x32_bf16 v[76:79], v[224:227], v[196:199], v[76:79]
  v_mfma_f32_16x16x32_bf16 v[80:83], v[224:227], v[200:203], v[80:83]
  ds_read_b64_tr_b16 v[224:225], v233 offset:33088
  ds_read_b64_tr_b16 v[226:227], v233 offset:34112
  ds_read_b128 v[212:215], v235 offset:16384
  s_waitcnt lgkmcnt(9)
  v_mfma_f32_16x16x32_bf16 v[84:87], v[228:231], v[192:195], v[84:87]
  s_add_u32 m0, s63, 36096
  s_add_u32 s64, s10, 163840
  buffer_load_dwordx4 v236, s[36:39], s64 offen lds
  v_mfma_f32_16x16x32_bf16 v[88:91], v[228:231], v[196:199], v[88:91]
  v_mfma_f32_16x16x32_bf16 v[92:95], v[228:231], v[200:203], v[92:95]
  ds_read_b64_tr_b16 v[228:229], v233 offset:33120
  ds_read_b64_tr_b16 v[230:231], v233 offset:34144
  s_waitcnt lgkmcnt(2)
  v_mfma_f32_16x16x32_bf16 v[0:3], v[216:219], v[204:207], v[0:3]
  s_cmp_lg_u32 s75, 1
  s_cbranch_scc1 Lkv1_6
  buffer_load_dwordx4 v[120:123], v239, s[28:31], s6 offen offset:1024 nt
  buffer_load_dwordx4 v[124:127], v239, s[28:31], s6 offen offset:3072 nt
  buffer_load_dwordx4 v[128:131], v240, s[28:31], 0 offen offset:0 nt
  buffer_load_dwordx4 v[132:135], v240, s[28:31], 0 offen offset:1024 nt
  buffer_load_dwordx4 v[136:139], v240, s[28:31], s7 offen offset:0 nt
  buffer_load_dwordx4 v[140:143], v240, s[28:31], s7 offen offset:1024 nt
Lkv1_6:
  v_mfma_f32_16x16x32_bf16 v[4:7], v[216:219], v[208:211], v[4:7]
  v_mfma_f32_16x16x32_bf16 v[8:11], v[216:219], v[212:215], v[8:11]
  ds_read_b64_tr_b16 v[216:217], v233 offset:33152
  ds_read_b64_tr_b16 v[218:219], v233 offset:34176
  v_mfma_f32_16x16x32_bf16 v[12:15], v[220:223], v[204:207], v[12:15]
  v_mfma_f32_16x16x32_bf16 v[16:19], v[220:223], v[208:211], v[16:19]
  v_mfma_f32_16x16x32_bf16 v[20:23], v[220:223], v[212:215], v[20:23]
  ds_read_b64_tr_b16 v[220:221], v233 offset:33184
  ds_read_b64_tr_b16 v[222:223], v233 offset:34208
  v_mfma_f32_16x16x32_bf16 v[24:27], v[224:227], v[204:207], v[24:27]
  v_mfma_f32_16x16x32_bf16 v[28:31], v[224:227], v[208:211], v[28:31]
  v_mfma_f32_16x16x32_bf16 v[32:35], v[224:227], v[212:215], v[32:35]
  ds_read_b64_tr_b16 v[224:225], v233 offset:33216
  ds_read_b64_tr_b16 v[226:227], v233 offset:34240
  s_waitcnt lgkmcnt(6)
  v_mfma_f32_16x16x32_bf16 v[36:39], v[228:231], v[204:207], v[36:39]
  v_mfma_f32_16x16x32_bf16 v[40:43], v[228:231], v[208:211], v[40:43]
  v_mfma_f32_16x16x32_bf16 v[44:47], v[228:231], v[212:215], v[44:47]
  s_cmp_lg_u32 s75, 0
  s_cbranch_scc1 Lw6_0
  s_waitcnt vmcnt(10)
  s_branch Lw6
Lw6_0:
  s_cmp_lg_u32 s75, 1
  s_cbranch_scc1 Lw6_1
  s_waitcnt vmcnt(10)
  s_branch Lw6
Lw6_1:
  s_waitcnt vmcnt(4)
Lw6:
  s_barrier
  ds_read_b64_tr_b16 v[228:229], v233 offset:33248
  ds_read_b64_tr_b16 v[230:231], v233 offset:34272
  s_waitcnt lgkmcnt(6)
  v_mfma_f32_16x16x32_bf16 v[48:51], v[216:219], v[204:207], v[48:51]
  s_add_u32 m0, s67, 12288
  s_add_u32 s64, s9, 5
  s_and_b32 s64, s64, 7
  s_lshl_b32 s64, s64, 7
  buffer_load_dwordx4 v237, s[24:27], s64 offen lds
  s_mov_b32 exec_hi, 0
  s_add_u32 m0, s68, 12288
  s_nop 0
  buffer_load_dwordx4 v238, s[24:27], s64 offen lds
  s_mov_b64 exec, -1
  v_mfma_f32_16x16x32_bf16 v[52:55], v[216:219], v[208:211], v[52:55]
  v_mfma_f32_16x16x32_bf16 v[56:59], v[216:219], v[212:215], v[56:59]
  ds_read_b64_tr_b16 v[216:217], v232 offset:0
  ds_read_b64_tr_b16 v[218:219], v232 offset:1024
  ds_read_b128 v[192:195], v234 offset:0
  s_waitcnt lgkmcnt(7)
  v_mfma_f32_16x16x32_bf16 v[60:63], v[220:223], v[204:207], v[60:63]
  s_lshl_b32 s10, s9, 1
  s_add_u32 s10, s10, 10
  s_and_b32 s10, s10, 15
  s_lshl_b32 s10, s10, 18
  s_add_u32 m0, s63, 66048
  s_add_u32 s64, s10, 0
  buffer_load_dwordx4 v236, s[36:39], s64 offen lds
  v_mfma_f32_16x16x32_bf16 v[64:67], v[220:223], v[208:211], v[64:67]
  v_mfma_f32_16x16x32_bf16 v[68:71], v[220:223], v[212:215], v[68:71]
  ds_read_b64_tr_b16 v[220:221], v232 offset:32
  ds_read_b64_tr_b16 v[222:223], v232 offset:1056
  ds_read_b128 v[196:199], v234 offset:2048
  s_waitcnt lgkmcnt(8)
  v_mfma_f32_16x16x32_bf16 v[72:75], v[224:227], v[204:207], v[72:75]
  s_add_u32 m0, s63, 67072
  s_add_u32 s64, s10, 32768
  buffer_load_dwordx4 v236, s[36:39], s64 offen lds
  v_mfma_f32_16x16x32_bf16 v[76:79], v[224:227], v[208:211], v[76:79]
  v_mfma_f32_16x16x32_bf16 v[80:83], v[224:227], v[212:215], v[80:83]
  ds_read_b64_tr_b16 v[224:225], v232 offset:64
  ds_read_b64_tr_b16 v[226:227], v232 offset:1088
  ds_read_b128 v[200:203], v234 offset:4096
  s_waitcnt lgkmcnt(9)
  v_mfma_f32_16x16x32_bf16 v[84:87], v[228:231], v[204:207], v[84:87]
  s_add_u32 m0, s63, 68096
  s_add_u32 s64, s10, 131072
  buffer_load_dwordx4 v236, s[36:39], s64 offen lds
  v_mfma_f32_16x16x32_bf16 v[88:91], v[228:231], v[208:211], v[88:91]
  v_mfma_f32_16x16x32_bf16 v[92:95], v[228:231], v[212:215], v[92:95]
  ds_read_b64_tr_b16 v[228:229], v232 offset:96
  ds_read_b64_tr_b16 v[230:231], v232 offset:1120
  s_waitcnt lgkmcnt(2)
  v_mfma_f32_16x16x32_bf16 v[0:3], v[216:219], v[192:195], v[0:3]
  s_add_u32 m0, s63, 69120
  s_add_u32 s64, s10, 163840
  buffer_load_dwordx4 v236, s[36:39], s64 offen lds
  v_mfma_f32_16x16x32_bf16 v[4:7], v[216:219], v[196:199], v[4:7]
  v_mfma_f32_16x16x32_bf16 v[8:11], v[216:219], v[200:203], v[8:11]
  ds_read_b64_tr_b16 v[216:217], v232 offset:128
  ds_read_b64_tr_b16 v[218:219], v232 offset:1152
  v_mfma_f32_16x16x32_bf16 v[12:15], v[220:223], v[192:195], v[12:15]
  s_cmp_lg_u32 s75, 2
  s_cbranch_scc1 Lkv2_6
  buffer_load_dwordx4 v[120:123], v239, s[28:31], s6 offen offset:1024 nt
  buffer_load_dwordx4 v[124:127], v239, s[28:31], s6 offen offset:3072 nt
  buffer_load_dwordx4 v[128:131], v240, s[28:31], 0 offen offset:0 nt
  buffer_load_dwordx4 v[132:135], v240, s[28:31], 0 offen offset:1024 nt
  buffer_load_dwordx4 v[136:139], v240, s[28:31], s7 offen offset:0 nt
  buffer_load_dwordx4 v[140:143], v240, s[28:31], s7 offen offset:1024 nt
Lkv2_6:
  v_mfma_f32_16x16x32_bf16 v[16:19], v[220:223], v[196:199], v[16:19]
  v_mfma_f32_16x16x32_bf16 v[20:23], v[220:223], v[200:203], v[20:23]
  ds_read_b64_tr_b16 v[220:221], v232 offset:160
  ds_read_b64_tr_b16 v[222:223], v232 offset:1184
  v_mfma_f32_16x16x32_bf16 v[24:27], v[224:227], v[192:195], v[24:27]
  v_mfma_f32_16x16x32_bf16 v[28:31], v[224:227], v[196:199], v[28:31]
  v_mfma_f32_16x16x32_bf16 v[32:35], v[224:227], v[200:203], v[32:35]
  ds_read_b64_tr_b16 v[224:225], v232 offset:192
  ds_read_b64_tr_b16 v[226:227], v232 offset:1216
  s_waitcnt lgkmcnt(6)
  v_mfma_f32_16x16x32_bf16 v[36:39], v[228:231], v[192:195], v[36:39]
  v_mfma_f32_16x16x32_bf16 v[40:43], v[228:231], v[196:199], v[40:43]
  v_mfma_f32_16x16x32_bf16 v[44:47], v[228:231], v[200:203], v[44:47]
  s_cmp_lg_u32 s75, 1
  s_cbranch_scc1 Lw7_1
  s_waitcnt vmcnt(12)
  s_branch Lw7
Lw7_1:
  s_cmp_lg_u32 s75, 2
  s_cbranch_scc1 Lw7_2
  s_waitcnt vmcnt(12)
  s_branch Lw7
Lw7_2:
  s_waitcnt vmcnt(6)
Lw7:
  s_barrier
  ds_read_b64_tr_b16 v[228:229], v232 offset:224
  ds_read_b64_tr_b16 v[230:231], v232 offset:1248
  s_waitcnt lgkmcnt(6)
  v_mfma_f32_16x16x32_bf16 v[48:51], v[216:219], v[192:195], v[48:51]
  s_lshl_b32 s10, s9, 1
  s_add_u32 s10, s10, 11
  s_and_b32 s10, s10, 15
  s_lshl_b32 s10, s10, 18
  s_add_u32 m0, s63, 99072
  s_add_u32 s64, s10, 0
  buffer_load_dwordx4 v236, s[36:39], s64 offen lds
  v_mfma_f32_16x16x32_bf16 v[52:55], v[216:219], v[196:199], v[52:55]
  v_mfma_f32_16x16x32_bf16 v[56:59], v[216:219], v[200:203], v[56:59]
  ds_read_b64_tr_b16 v[216:217], v232 offset:33024
  ds_read_b64_tr_b16 v[218:219], v232 offset:34048
  ds_read_b128 v[204:207], v235 offset:0
  s_waitcnt lgkmcnt(7)
  v_mfma_f32_16x16x32_bf16 v[60:63], v[220:223], v[192:195], v[60:63]
  s_add_u32 m0, s63, 100096
  s_add_u32 s64, s10, 32768
  buffer_load_dwordx4 v236, s[36:39], s64 offen lds
  v_mfma_f32_16x16x32_bf16 v[64:67], v[220:223], v[196:199], v[64:67]
  v_mfma_f32_16x16x32_bf16 v[68:71], v[220:223], v[200:203], v[68:71]
  ds_read_b64_tr_b16 v[220:221], v232 offset:33056
  ds_read_b64_tr_b16 v[222:223], v232 offset:34080
  ds_read_b128 v[208:211], v235 offset:2048
  s_waitcnt lgkmcnt(8)
  v_mfma_f32_16x16x32_bf16 v[72:75], v[224:227], v[192:195], v[72:75]
  s_add_u32 m0, s63, 101120
  s_add_u32 s64, s10, 131072
  buffer_load_dwordx4 v236, s[36:39], s64 offen lds
  v_mfma_f32_16x16x32_bf16 v[76:79], v[224:227], v[196:199], v[76:79]
  v_mfma_f32_16x16x32_bf16 v[80:83], v[224:227], v[200:203], v[80:83]
  ds_read_b64_tr_b16 v[224:225], v232 offset:33088
  ds_read_b64_tr_b16 v[226:227], v232 offset:34112
  ds_read_b128 v[212:215], v235 offset:4096
  s_waitcnt lgkmcnt(9)
  v_mfma_f32_16x16x32_bf16 v[84:87], v[228:231], v[192:195], v[84:87]
  s_add_u32 m0, s63, 102144
  s_add_u32 s64, s10, 163840
  buffer_load_dwordx4 v236, s[36:39], s64 offen lds
  v_mfma_f32_16x16x32_bf16 v[88:91], v[228:231], v[196:199], v[88:91]
  v_mfma_f32_16x16x32_bf16 v[92:95], v[228:231], v[200:203], v[92:95]
  ds_read_b64_tr_b16 v[228:229], v232 offset:33120
  ds_read_b64_tr_b16 v[230:231], v232 offset:34144
  s_waitcnt lgkmcnt(2)
  v_mfma_f32_16x16x32_bf16 v[0:3], v[216:219], v[204:207], v[0:3]
  s_cmp_lg_u32 s75, 3
  s_cbranch_scc1 Lkv3_6
  buffer_load_dwordx4 v[120:123], v239, s[28:31], s6 offen offset:1024 nt
  buffer_load_dwordx4 v[124:127], v239, s[28:31], s6 offen offset:3072 nt
  buffer_load_dwordx4 v[128:131], v240, s[28:31], 0 offen offset:0 nt
  buffer_load_dwordx4 v[132:135], v240, s[28:31], 0 offen offset:1024 nt
  buffer_load_dwordx4 v[136:139], v240, s[28:31], s7 offen offset:0 nt
  buffer_load_dwordx4 v[140:143], v240, s[28:31], s7 offen offset:1024 nt
Lkv3_6:
  v_mfma_f32_16x16x32_bf16 v[4:7], v[216:219], v[208:211], v[4:7]
  v_mfma_f32_16x16x32_bf16 v[8:11], v[216:219], v[212:215], v[8:11]
  ds_read_b64_tr_b16 v[216:217], v232 offset:33152
  ds_read_b64_tr_b16 v[218:219], v232 offset:34176
  v_mfma_f32_16x16x32_bf16 v[12:15], v[220:223], v[204:207], v[12:15]
  v_mfma_f32_16x16x32_bf16 v[16:19], v[220:223], v[208:211], v[16:19]
  v_mfma_f32_16x16x32_bf16 v[20:23], v[220:223], v[212:215], v[20:23]
  ds_read_b64_tr_b16 v[220:221], v232 offset:33184
  ds_read_b64_tr_b16 v[222:223], v232 offset:34208
  v_mfma_f32_16x16x32_bf16 v[24:27], v[224:227], v[204:207], v[24:27]
  v_mfma_f32_16x16x32_bf16 v[28:31], v[224:227], v[208:211], v[28:31]
  v_mfma_f32_16x16x32_bf16 v[32:35], v[224:227], v[212:215], v[32:35]
  ds_read_b64_tr_b16 v[224:225], v232 offset:33216
  ds_read_b64_tr_b16 v[226:227], v232 offset:34240
  s_waitcnt lgkmcnt(6)
  v_mfma_f32_16x16x32_bf16 v[36:39], v[228:231], v[204:207], v[36:39]
  v_mfma_f32_16x16x32_bf16 v[40:43], v[228:231], v[208:211], v[40:43]
  v_mfma_f32_16x16x32_bf16 v[44:47], v[228:231], v[212:215], v[44:47]
  s_cmp_lg_u32 s75, 2
  s_cbranch_scc1 Lw8_2
  s_waitcnt vmcnt(10)
  s_branch Lw8
Lw8_2:
  s_cmp_lg_u32 s75, 3
  s_cbranch_scc1 Lw8_3
  s_waitcnt vmcnt(10)
  s_branch Lw8
Lw8_3:
  s_waitcnt vmcnt(4)
Lw8:
  s_barrier
  ds_read_b64_tr_b16 v[228:229], v232 offset:33248
  ds_read_b64_tr_b16 v[230:231], v232 offset:34272
  s_waitcnt lgkmcnt(6)
  v_mfma_f32_16x16x32_bf16 v[48:51], v[216:219], v[204:207], v[48:51]
  s_add_u32 m0, s67, 0
  s_add_u32 s64, s9, 6
  s_and_b32 s64, s64, 7
  s_lshl_b32 s64, s64, 7
  buffer_load_dwordx4 v237, s[24:27], s64 offen lds
  s_mov_b32 exec_hi, 0
  s_add_u32 m0, s68, 0
  s_nop 0
  buffer_load_dwordx4 v238, s[24:27], s64 offen lds
  s_mov_b64 exec, -1
  v_mfma_f32_16x16x32_bf16 v[52:55], v[216:219], v[208:211], v[52:55]
  v_mfma_f32_16x16x32_bf16 v[56:59], v[216:219], v[212:215], v[56:59]
  ds_read_b64_tr_b16 v[216:217], v233 offset:0
  ds_read_b64_tr_b16 v[218:219], v233 offset:1024
  ds_read_b128 v[192:195], v234 offset:12288
  s_waitcnt lgkmcnt(7)
  v_mfma_f32_16x16x32_bf16 v[60:63], v[220:223], v[204:207], v[60:63]
  s_lshl_b32 s10, s9, 1
  s_add_u32 s10, s10, 12
  s_and_b32 s10, s10, 15
  s_lshl_b32 s10, s10, 18
  s_add_u32 m0, s63, 0
  s_add_u32 s64, s10, 0
  buffer_load_dwordx4 v236, s[36:39], s64 offen lds
  v_mfma_f32_16x16x32_bf16 v[64:67], v[220:223], v[208:211], v[64:67]
  v_mfma_f32_16x16x32_bf16 v[68:71], v[220:223], v[212:215], v[68:71]
  ds_read_b64_tr_b16 v[220:221], v233 offset:32
  ds_read_b64_tr_b16 v[222:223], v233 offset:1056
  ds_read_b128 v[196:199], v234 offset:14336
  s_waitcnt lgkmcnt(8)
  v_mfma_f32_16x16x32_bf16 v[72:75], v[224:227], v[204:207], v[72:75]
  s_add_u32 m0, s63, 1024
  s_add_u32 s64, s10, 32768
  buffer_load_dwordx4 v236, s[36:39], s64 offen lds
  v_mfma_f32_16x16x32_bf16 v[76:79], v[224:227], v[208:211], v[76:79]
  v_mfma_f32_16x16x32_bf16 v[80:83], v[224:227], v[212:215], v[80:83]
  ds_read_b64_tr_b16 v[224:225], v233 offset:64
  ds_read_b64_tr_b16 v[226:227], v233 offset:1088
  ds_read_b128 v[200:203], v234 offset:16384
  s_waitcnt lgkmcnt(9)
  v_mfma_f32_16x16x32_bf16 v[84:87], v[228:231], v[204:207], v[84:87]
  s_add_u32 m0, s63, 2048
  s_add_u32 s64, s10, 131072
  buffer_load_dwordx4 v236, s[36:39], s64 offen lds
  v_mfma_f32_16x16x32_bf16 v[88:91], v[228:231], v[208:211], v[88:91]
  v_mfma_f32_16x16x32_bf16 v[92:95], v[228:231], v[212:215], v[92:95]
  ds_read_b64_tr_b16 v[228:229], v233 offset:96
  ds_read_b64_tr_b16 v[230:231], v233 offset:1120
  s_waitcnt lgkmcnt(2)
  v_mfma_f32_16x16x32_bf16 v[0:3], v[216:219], v[192:195], v[0:3]
  s_add_u32 m0, s63, 3072
  s_add_u32 s64, s10, 163840
  buffer_load_dwordx4 v236, s[36:39], s64 offen lds
  v_mfma_f32_16x16x32_bf16 v[4:7], v[216:219], v[196:199], v[4:7]
  v_mfma_f32_16x16x32_bf16 v[8:11], v[216:219], v[200:203], v[8:11]
  ds_read_b64_tr_b16 v[216:217], v233 offset:128
  ds_read_b64_tr_b16 v[218:219], v233 offset:1152
  v_mfma_f32_16x16x32_bf16 v[12:15], v[220:223], v[192:195], v[12:15]
  v_mfma_f32_16x16x32_bf16 v[16:19], v[220:223], v[196:199], v[16:19]
  v_mfma_f32_16x16x32_bf16 v[20:23], v[220:223], v[200:203], v[20:23]
  ds_read_b64_tr_b16 v[220:221], v233 offset:160
  ds_read_b64_tr_b16 v[222:223], v233 offset:1184
  v_mfma_f32_16x16x32_bf16 v[24:27], v[224:227], v[192:195], v[24:27]
  v_mfma_f32_16x16x32_bf16 v[28:31], v[224:227], v[196:199], v[28:31]
  v_mfma_f32_16x16x32_bf16 v[32:35], v[224:227], v[200:203], v[32:35]
  ds_read_b64_tr_b16 v[224:225], v233 offset:192
  ds_read_b64_tr_b16 v[226:227], v233 offset:1216
  s_waitcnt lgkmcnt(6)
  v_mfma_f32_16x16x32_bf16 v[36:39], v[228:231], v[192:195], v[36:39]
  v_mfma_f32_16x16x32_bf16 v[40:43], v[228:231], v[196:199], v[40:43]
  v_mfma_f32_16x16x32_bf16 v[44:47], v[228:231], v[200:203], v[44:47]
  s_cmp_lg_u32 s75, 3
  s_cbranch_scc1 Lw9_3
  s_waitcnt vmcnt(12)
  s_branch Lw9
Lw9_3:
  s_waitcnt vmcnt(6)
Lw9:
  s_barrier
  ds_read_b64_tr_b16 v[228:229], v233 offset:224
  ds_read_b64_tr_b16 v[230:231], v233 offset:1248
  s_waitcnt lgkmcnt(6)
  v_mfma_f32_16x16x32_bf16 v[48:51], v[216:219], v[192:195], v[48:51]
  s_lshl_b32 s10, s9, 1
  s_add_u32 s10, s10, 13
  s_and_b32 s10, s10, 15
  s_lshl_b32 s10, s10, 18
  s_add_u32 m0, s63, 33024
  s_add_u32 s64, s10, 0
  buffer_load_dwordx4 v236, s[36:39], s64 offen lds
  v_mfma_f32_16x16x32_bf16 v[52:55], v[216:219], v[196:199], v[52:55]
  v_mfma_f32_16x16x32_bf16 v[56:59], v[216:219], v[200:203], v[56:59]
  ds_read_b64_tr_b16 v[216:217], v233 offset:33024
  ds_read_b64_tr_b16 v[218:219], v233 offset:34048
  ds_read_b128 v[204:207], v235 offset:12288
  s_waitcnt lgkmcnt(7)
  v_mfma_f32_16x16x32_bf16 v[60:63], v[220:223], v[192:195], v[60:63]
  s_add_u32 m0, s63, 34048
  s_add_u32 s64, s10, 32768
  buffer_load_dwordx4 v236, s[36:39], s64 offen lds
  v_mfma_f32_16x16x32_bf16 v[64:67], v[220:223], v[196:199], v[64:67]
  v_mfma_f32_16x16x32_bf16 v[68:71], v[220:223], v[200:203], v[68:71]
  ds_read_b64_tr_b16 v[220:221], v233 offset:33056
  ds_read_b64_tr_b16 v[222:223], v233 offset:34080
  ds_read_b128 v[208:211], v235 offset:14336
  s_waitcnt lgkmcnt(8)
  v_mfma_f32_16x16x32_bf16 v[72:75], v[224:227], v[192:195], v[72:75]
  s_add_u32 m0, s63, 35072
  s_add_u32 s64, s10, 131072
  buffer_load_dwordx4 v236, s[36:39], s64 offen lds
  v_mfma_f32_16x16x32_bf16 v[76:79], v[224:227], v[196:199], v[76:79]
  v_mfma_f32_16x16x32_bf16 v[80:83], v[224:227], v[200:203], v[80:83]
  ds_read_b64_tr_b16 v[224:225], v233 offset:33088
  ds_read_b64_tr_b16 v[226:227], v233 offset:34112
  ds_read_b128 v[212:215], v235 offset:16384
  s_waitcnt lgkmcnt(9)
  v_mfma_f32_16x16x32_bf16 v[84:87], v[228:231], v[192:195], v[84:87]
  s_add_u32 m0, s63, 36096
  s_add_u32 s64, s10, 163840
  buffer_load_dwordx4 v236, s[36:39], s64 offen lds
  v_mfma_f32_16x16x32_bf16 v[88:91], v[228:231], v[196:199], v[88:91]
  v_mfma_f32_16x16x32_bf16 v[92:95], v[228:231], v[200:203], v[92:95]
  ds_read_b64_tr_b16 v[228:229], v233 offset:33120
  ds_read_b64_tr_b16 v[230:231], v233 offset:34144
  s_waitcnt lgkmcnt(2)
  v_mfma_f32_16x16x32_bf16 v[0:3], v[216:219], v[204:207], v[0:3]
  v_mfma_f32_16x16x32_bf16 v[4:7], v[216:219], v[208:211], v[4:7]
  v_mfma_f32_16x16x32_bf16 v[8:11], v[216:219], v[212:215], v[8:11]
  ds_read_b64_tr_b16 v[216:217], v233 offset:33152
  ds_read_b64_tr_b16 v[218:219], v233 offset:34176
  v_mfma_f32_16x16x32_bf16 v[12:15], v[220:223], v[204:207], v[12:15]
  v_mfma_f32_16x16x32_bf16 v[16:19], v[220:223], v[208:211], v[16:19]
  v_mfma_f32_16x16x32_bf16 v[20:23], v[220:223], v[212:215], v[20:23]
  ds_read_b64_tr_b16 v[220:221], v233 offset:33184
  ds_read_b64_tr_b16 v[222:223], v233 offset:34208
  v_mfma_f32_16x16x32_bf16 v[24:27], v[224:227], v[204:207], v[24:27]
  v_mfma_f32_16x16x32_bf16 v[28:31], v[224:227], v[208:211], v[28:31]
  v_mfma_f32_16x16x32_bf16 v[32:35], v[224:227], v[212:215], v[32:35]
  ds_read_b64_tr_b16 v[224:225], v233 offset:33216
  ds_read_b64_tr_b16 v[226:227], v233 offset:34240
  s_waitcnt lgkmcnt(6)
  v_mfma_f32_16x16x32_bf16 v[36:39], v[228:231], v[204:207], v[36:39]
  v_mfma_f32_16x16x32_bf16 v[40:43], v[228:231], v[208:211], v[40:43]
  v_mfma_f32_16x16x32_bf16 v[44:47], v[228:231], v[212:215], v[44:47]
  s_waitcnt vmcnt(4)
  s_barrier
  ds_read_b64_tr_b16 v[228:229], v233 offset:33248
  ds_read_b64_tr_b16 v[230:231], v233 offset:34272
  s_waitcnt lgkmcnt(6)
  v_mfma_f32_16x16x32_bf16 v[48:51], v[216:219], v[204:207], v[48:51]
  s_add_u32 m0, s67, 12288
  s_add_u32 s64, s9, 7
  s_and_b32 s64, s64, 7
  s_lshl_b32 s64, s64, 7
  buffer_load_dwordx4 v237, s[24:27], s64 offen lds
  s_mov_b32 exec_hi, 0
  s_add_u32 m0, s68, 12288
  s_nop 0
  buffer_load_dwordx4 v238, s[24:27], s64 offen lds
  s_mov_b64 exec, -1
  v_mfma_f32_16x16x32_bf16 v[52:55], v[216:219], v[208:211], v[52:55]
  v_mfma_f32_16x16x32_bf16 v[56:59], v[216:219], v[212:215], v[56:59]
  ds_read_b64_tr_b16 v[216:217], v232 offset:0
  ds_read_b64_tr_b16 v[218:219], v232 offset:1024
  ds_read_b128 v[192:195], v234 offset:0
  s_waitcnt lgkmcnt(7)
  v_mfma_f32_16x16x32_bf16 v[60:63], v[220:223], v[204:207], v[60:63]
  s_lshl_b32 s10, s9, 1
  s_add_u32 s10, s10, 14
  s_and_b32 s10, s10, 15
  s_lshl_b32 s10, s10, 18
  s_add_u32 m0, s63, 66048
  s_add_u32 s64, s10, 0
  buffer_load_dwordx4 v236, s[36:39], s64 offen lds
  v_mfma_f32_16x16x32_bf16 v[64:67], v[220:223], v[208:211], v[64:67]
  v_mfma_f32_16x16x32_bf16 v[68:71], v[220:223], v[212:215], v[68:71]
  ds_read_b64_tr_b16 v[220:221], v232 offset:32
  ds_read_b64_tr_b16 v[222:223], v232 offset:1056
  ds_read_b128 v[196:199], v234 offset:2048
  s_waitcnt lgkmcnt(8)
  v_mfma_f32_16x16x32_bf16 v[72:75], v[224:227], v[204:207], v[72:75]
  s_add_u32 m0, s63, 67072
  s_add_u32 s64, s10, 32768
  buffer_load_dwordx4 v236, s[36:39], s64 offen lds
  v_mfma_f32_16x16x32_bf16 v[76:79], v[224:227], v[208:211], v[76:79]
  v_mfma_f32_16x16x32_bf16 v[80:83], v[224:227], v[212:215], v[80:83]
  ds_read_b64_tr_b16 v[224:225], v232 offset:64
  ds_read_b64_tr_b16 v[226:227], v232 offset:1088
  ds_read_b128 v[200:203], v234 offset:4096
  s_waitcnt lgkmcnt(9)
  v_mfma_f32_16x16x32_bf16 v[84:87], v[228:231], v[204:207], v[84:87]
  s_add_u32 m0, s63, 68096
  s_add_u32 s64, s10, 131072
  buffer_load_dwordx4 v236, s[36:39], s64 offen lds
  v_mfma_f32_16x16x32_bf16 v[88:91], v[228:231], v[208:211], v[88:91]
  v_mfma_f32_16x16x32_bf16 v[92:95], v[228:231], v[212:215], v[92:95]
  ds_read_b64_tr_b16 v[228:229], v232 offset:96
  ds_read_b64_tr_b16 v[230:231], v232 offset:1120
  s_waitcnt lgkmcnt(2)
  v_mfma_f32_16x16x32_bf16 v[0:3], v[216:219], v[192:195], v[0:3]
  s_add_u32 m0, s63, 69120
  s_add_u32 s64, s10, 163840
  buffer_load_dwordx4 v236, s[36:39], s64 offen lds
  v_mfma_f32_16x16x32_bf16 v[4:7], v[216:219], v[196:199], v[4:7]
  v_mfma_f32_16x16x32_bf16 v[8:11], v[216:219], v[200:203], v[8:11]
  ds_read_b64_tr_b16 v[216:217], v232 offset:128
  ds_read_b64_tr_b16 v[218:219], v232 offset:1152
  v_mfma_f32_16x16x32_bf16 v[12:15], v[220:223], v[192:195], v[12:15]
  v_mfma_f32_16x16x32_bf16 v[16:19], v[220:223], v[196:199], v[16:19]
  v_mfma_f32_16x16x32_bf16 v[20:23], v[220:223], v[200:203], v[20:23]
  ds_read_b64_tr_b16 v[220:221], v232 offset:160
  ds_read_b64_tr_b16 v[222:223], v232 offset:1184
  v_mfma_f32_16x16x32_bf16 v[24:27], v[224:227], v[192:195], v[24:27]
  v_mfma_f32_16x16x32_bf16 v[28:31], v[224:227], v[196:199], v[28:31]
  v_mfma_f32_16x16x32_bf16 v[32:35], v[224:227], v[200:203], v[32:35]
  ds_read_b64_tr_b16 v[224:225], v232 offset:192
  ds_read_b64_tr_b16 v[226:227], v232 offset:1216
  s_waitcnt lgkmcnt(6)
  v_mfma_f32_16x16x32_bf16 v[36:39], v[228:231], v[192:195], v[36:39]
  v_mfma_f32_16x16x32_bf16 v[40:43], v[228:231], v[196:199], v[40:43]
  v_mfma_f32_16x16x32_bf16 v[44:47], v[228:231], v[200:203], v[44:47]
  s_waitcnt vmcnt(6)
  s_barrier
  ds_read_b64_tr_b16 v[228:229], v232 offset:224
  ds_read_b64_tr_b16 v[230:231], v232 offset:1248
  s_waitcnt lgkmcnt(6)
  v_mfma_f32_16x16x32_bf16 v[48:51], v[216:219], v[192:195], v[48:51]
  s_lshl_b32 s10, s9, 1
  s_add_u32 s10, s10, 15
  s_and_b32 s10, s10, 15
  s_lshl_b32 s10, s10, 18
  s_add_u32 m0, s63, 99072
  s_add_u32 s64, s10, 0
  buffer_load_dwordx4 v236, s[36:39], s64 offen lds
  v_mfma_f32_16x16x32_bf16 v[52:55], v[216:219], v[196:199], v[52:55]
  v_mfma_f32_16x16x32_bf16 v[56:59], v[216:219], v[200:203], v[56:59]
  ds_read_b64_tr_b16 v[216:217], v232 offset:33024
  ds_read_b64_tr_b16 v[218:219], v232 offset:34048
  ds_read_b128 v[204:207], v235 offset:0
  s_waitcnt lgkmcnt(7)
  v_mfma_f32_16x16x32_bf16 v[60:63], v[220:223], v[192:195], v[60:63]
  s_add_u32 m0, s63, 100096
  s_add_u32 s64, s10, 32768
  buffer_load_dwordx4 v236, s[36:39], s64 offen lds
  v_mfma_f32_16x16x32_bf16 v[64:67], v[220:223], v[196:199], v[64:67]
  v_mfma_f32_16x16x32_bf16 v[68:71], v[220:223], v[200:203], v[68:71]
  ds_read_b64_tr_b16 v[220:221], v232 offset:33056
  ds_read_b64_tr_b16 v[222:223], v232 offset:34080
  ds_read_b128 v[208:211], v235 offset:2048
  s_waitcnt lgkmcnt(8)
  v_mfma_f32_16x16x32_bf16 v[72:75], v[224:227], v[192:195], v[72:75]
  s_add_u32 m0, s63, 101120
  s_add_u32 s64, s10, 131072
  buffer_load_dwordx4 v236, s[36:39], s64 offen lds
  v_mfma_f32_16x16x32_bf16 v[76:79], v[224:227], v[196:199], v[76:79]
  v_mfma_f32_16x16x32_bf16 v[80:83], v[224:227], v[200:203], v[80:83]
  ds_read_b64_tr_b16 v[224:225], v232 offset:33088
  ds_read_b64_tr_b16 v[226:227], v232 offset:34112
  ds_read_b128 v[212:215], v235 offset:4096
  s_waitcnt lgkmcnt(9)
  v_mfma_f32_16x16x32_bf16 v[84:87], v[228:231], v[192:195], v[84:87]
  s_add_u32 m0, s63, 102144
  s_add_u32 s64, s10, 163840
  buffer_load_dwordx4 v236, s[36:39], s64 offen lds
  v_mfma_f32_16x16x32_bf16 v[88:91], v[228:231], v[196:199], v[88:91]
  v_mfma_f32_16x16x32_bf16 v[92:95], v[228:231], v[200:203], v[92:95]
  ds_read_b64_tr_b16 v[228:229], v232 offset:33120
  ds_read_b64_tr_b16 v[230:231], v232 offset:34144
  s_waitcnt lgkmcnt(2)
  v_mfma_f32_16x16x32_bf16 v[0:3], v[216:219], v[204:207], v[0:3]
  s_cmp_lg_u32 s75, 0
  s_cbranch_scc1 Lkv0_12
  buffer_load_dwordx4 v[144:147], v241, s[32:35], 0 offen offset:0 nt
  buffer_load_dwordx4 v[148:151], v241, s[32:35], 0 offen offset:256 nt
  buffer_load_dwordx4 v[152:155], v241, s[32:35], 0 offen offset:512 nt
  buffer_load_dwordx4 v[156:159], v241, s[32:35], 0 offen offset:768 nt
Lkv0_12:
  s_cmp_lg_u32 s75, 1
  s_cbranch_scc1 Lkv1_12
  buffer_load_dwordx4 v[144:147], v241, s[32:35], 0 offen offset:0 nt
  buffer_load_dwordx4 v[148:151], v241, s[32:35], 0 offen offset:256 nt
  buffer_load_dwordx4 v[152:155], v241, s[32:35], 0 offen offset:512 nt
  buffer_load_dwordx4 v[156:159], v241, s[32:35], 0 offen offset:768 nt
Lkv1_12:
  s_cmp_lg_u32 s75, 2
  s_cbranch_scc1 Lkv2_12
  buffer_load_dwordx4 v[144:147], v241, s[32:35], 0 offen offset:0 nt
  buffer_load_dwordx4 v[148:151], v241, s[32:35], 0 offen offset:256 nt
  buffer_load_dwordx4 v[152:155], v241, s[32:35], 0 offen offset:512 nt
  buffer_load_dwordx4 v[156:159], v241, s[32:35], 0 offen offset:768 nt
Lkv2_12:
  s_cmp_lg_u32 s75, 3
  s_cbranch_scc1 Lkv3_12
  buffer_load_dwordx4 v[144:147], v241, s[32:35], 0 offen offset:0 nt
  buffer_load_dwordx4 v[148:151], v241, s[32:35], 0 offen offset:256 nt
  buffer_load_dwordx4 v[152:155], v241, s[32:35], 0 offen offset:512 nt
  buffer_load_dwordx4 v[156:159], v241, s[32:35], 0 offen offset:768 nt
Lkv3_12:
  v_mfma_f32_16x16x32_bf16 v[4:7], v[216:219], v[208:211], v[4:7]
  v_mfma_f32_16x16x32_bf16 v[8:11], v[216:219], v[212:215], v[8:11]
  ds_read_b64_tr_b16 v[216:217], v232 offset:33152
  ds_read_b64_tr_b16 v[218:219], v232 offset:34176
  v_mfma_f32_16x16x32_bf16 v[12:15], v[220:223], v[204:207], v[12:15]
  s_mul_i32 s64, s56, 4352
  s_add_u32 s64, s64, 33024
  s_cmp_eq_u32 s56, 7
  s_cselect_b32 s64, 132096, s64
  v_lshrrev_b32 v251, 8, v247
  v_mul_u32_u24 v249, 272, v251
  v_and_b32 v250, 0xf0, v247
  v_add3_u32 v237, v249, v250, s64
  v_mul_u32_u24 v250, 17, v250
  v_lshl_add_u32 v250, v251, 3, v250
  v_add_u32 v238, s64, v250
  v_mfma_f32_16x16x32_bf16 v[16:19], v[220:223], v[208:211], v[16:19]
  v_mfma_f32_16x16x32_bf16 v[20:23], v[220:223], v[212:215], v[20:23]
  ds_read_b64_tr_b16 v[220:221], v232 offset:33184
  ds_read_b64_tr_b16 v[222:223], v232 offset:34208
  v_mfma_f32_16x16x32_bf16 v[24:27], v[224:227], v[204:207], v[24:27]
  v_mfma_f32_16x16x32_bf16 v[28:31], v[224:227], v[208:211], v[28:31]
  v_mfma_f32_16x16x32_bf16 v[32:35], v[224:227], v[212:215], v[32:35]
  ds_read_b64_tr_b16 v[224:225], v232 offset:33216
  ds_read_b64_tr_b16 v[226:227], v232 offset:34240
  s_waitcnt lgkmcnt(6)
  v_mfma_f32_16x16x32_bf16 v[36:39], v[228:231], v[204:207], v[36:39]
  v_mfma_f32_16x16x32_bf16 v[40:43], v[228:231], v[208:211], v[40:43]
  v_mfma_f32_16x16x32_bf16 v[44:47], v[228:231], v[212:215], v[44:47]
  s_waitcnt vmcnt(8)
  s_barrier
  ds_read_b64_tr_b16 v[228:229], v232 offset:33248
  ds_read_b64_tr_b16 v[230:231], v232 offset:34272
  s_waitcnt lgkmcnt(6)
  v_mfma_f32_16x16x32_bf16 v[48:51], v[216:219], v[204:207], v[48:51]
  v_mfma_f32_16x16x32_bf16 v[52:55], v[216:219], v[208:211], v[52:55]
  v_mfma_f32_16x16x32_bf16 v[56:59], v[216:219], v[212:215], v[56:59]
  ds_read_b64_tr_b16 v[216:217], v233 offset:0
  ds_read_b64_tr_b16 v[218:219], v233 offset:1024
  ds_read_b128 v[192:195], v234 offset:12288
  s_waitcnt lgkmcnt(7)
  v_mfma_f32_16x16x32_bf16 v[60:63], v[220:223], v[204:207], v[60:63]
  v_mfma_f32_16x16x32_bf16 v[64:67], v[220:223], v[208:211], v[64:67]
  v_mfma_f32_16x16x32_bf16 v[68:71], v[220:223], v[212:215], v[68:71]
  ds_read_b64_tr_b16 v[220:221], v233 offset:32
  ds_read_b64_tr_b16 v[222:223], v233 offset:1056
  ds_read_b128 v[196:199], v234 offset:14336
  s_waitcnt lgkmcnt(8)
  v_mfma_f32_16x16x32_bf16 v[72:75], v[224:227], v[204:207], v[72:75]
  v_mfma_f32_16x16x32_bf16 v[76:79], v[224:227], v[208:211], v[76:79]
  v_mfma_f32_16x16x32_bf16 v[80:83], v[224:227], v[212:215], v[80:83]
  ds_read_b64_tr_b16 v[224:225], v233 offset:64
  ds_read_b64_tr_b16 v[226:227], v233 offset:1088
  ds_read_b128 v[200:203], v234 offset:16384
  s_waitcnt lgkmcnt(9)
  v_mfma_f32_16x16x32_bf16 v[84:87], v[228:231], v[204:207], v[84:87]
  v_mfma_f32_16x16x32_bf16 v[88:91], v[228:231], v[208:211], v[88:91]
  v_mfma_f32_16x16x32_bf16 v[92:95], v[228:231], v[212:215], v[92:95]
  ds_read_b64_tr_b16 v[228:229], v233 offset:96
  ds_read_b64_tr_b16 v[230:231], v233 offset:1120
  s_waitcnt lgkmcnt(2)
  v_mfma_f32_16x16x32_bf16 v[0:3], v[216:219], v[192:195], v[0:3]
  v_mfma_f32_16x16x32_bf16 v[4:7], v[216:219], v[196:199], v[4:7]
  v_mfma_f32_16x16x32_bf16 v[8:11], v[216:219], v[200:203], v[8:11]
  ds_read_b64_tr_b16 v[216:217], v233 offset:128
  ds_read_b64_tr_b16 v[218:219], v233 offset:1152
  v_mfma_f32_16x16x32_bf16 v[12:15], v[220:223], v[192:195], v[12:15]
  v_mfma_f32_16x16x32_bf16 v[16:19], v[220:223], v[196:199], v[16:19]
  v_mfma_f32_16x16x32_bf16 v[20:23], v[220:223], v[200:203], v[20:23]
  ds_read_b64_tr_b16 v[220:221], v233 offset:160
  ds_read_b64_tr_b16 v[222:223], v233 offset:1184
  v_mfma_f32_16x16x32_bf16 v[24:27], v[224:227], v[192:195], v[24:27]
  v_mfma_f32_16x16x32_bf16 v[28:31], v[224:227], v[196:199], v[28:31]
  v_mfma_f32_16x16x32_bf16 v[32:35], v[224:227], v[200:203], v[32:35]
  ds_read_b64_tr_b16 v[224:225], v233 offset:192
  ds_read_b64_tr_b16 v[226:227], v233 offset:1216
  s_waitcnt lgkmcnt(6)
  v_mfma_f32_16x16x32_bf16 v[36:39], v[228:231], v[192:195], v[36:39]
  v_mfma_f32_16x16x32_bf16 v[40:43], v[228:231], v[196:199], v[40:43]
  v_mfma_f32_16x16x32_bf16 v[44:47], v[228:231], v[200:203], v[44:47]
  s_waitcnt vmcnt(4)
  s_barrier
  ds_read_b64_tr_b16 v[228:229], v233 offset:224
  ds_read_b64_tr_b16 v[230:231], v233 offset:1248
  s_waitcnt lgkmcnt(6)
  v_mfma_f32_16x16x32_bf16 v[48:51], v[216:219], v[192:195], v[48:51]
  s_cmp_lg_u32 s75, 0
  s_cbranch_scc1 Lkv0_16
  buffer_load_dwordx4 v[160:163], v241, s[32:35], 0 offen offset:1024 nt
  buffer_load_dwordx4 v[164:167], v241, s[32:35], 0 offen offset:1280 nt
  buffer_load_dwordx4 v[168:171], v241, s[32:35], 0 offen offset:1536 nt
  buffer_load_dwordx4 v[172:175], v241, s[32:35], 0 offen offset:1792 nt
Lkv0_16:
  s_cmp_lg_u32 s75, 1
  s_cbranch_scc1 Lkv1_16
  buffer_load_dwordx4 v[160:163], v241, s[32:35], 0 offen offset:1024 nt
  buffer_load_dwordx4 v[164:167], v241, s[32:35], 0 offen offset:1280 nt
  buffer_load_dwordx4 v[168:171], v241, s[32:35], 0 offen offset:1536 nt
  buffer_load_dwordx4 v[172:175], v241, s[32:35], 0 offen offset:1792 nt
Lkv1_16:
  s_cmp_lg_u32 s75, 2
  s_cbranch_scc1 Lkv2_16
  buffer_load_dwordx4 v[160:163], v241, s[32:35], 0 offen offset:1024 nt
  buffer_load_dwordx4 v[164:167], v241, s[32:35], 0 offen offset:1280 nt
  buffer_load_dwordx4 v[168:171], v241, s[32:35], 0 offen offset:1536 nt
  buffer_load_dwordx4 v[172:175], v241, s[32:35], 0 offen offset:1792 nt
Lkv2_16:
  s_cmp_lg_u32 s75, 3
  s_cbranch_scc1 Lkv3_16
  buffer_load_dwordx4 v[160:163], v241, s[32:35], 0 offen offset:1024 nt
  buffer_load_dwordx4 v[164:167], v241, s[32:35], 0 offen offset:1280 nt
  buffer_load_dwordx4 v[168:171], v241, s[32:35], 0 offen offset:1536 nt
  buffer_load_dwordx4 v[172:175], v241, s[32:35], 0 offen offset:1792 nt
Lkv3_16:
  v_mfma_f32_16x16x32_bf16 v[52:55], v[216:219], v[196:199], v[52:55]
  ds_write_b128 v237, v[96:99] offset:0
  ds_write_b128 v237, v[100:103] offset:1088
  ds_write_b128 v237, v[104:107] offset:2176
  ds_write_b128 v237, v[108:111] offset:3264
  v_mfma_f32_16x16x32_bf16 v[56:59], v[216:219], v[200:203], v[56:59]
  ds_read_b64_tr_b16 v[216:217], v233 offset:33024
  ds_read_b64_tr_b16 v[218:219], v233 offset:34048
  ds_read_b128 v[204:207], v235 offset:12288
  s_waitcnt lgkmcnt(11)
  v_mfma_f32_16x16x32_bf16 v[60:63], v[220:223], v[192:195], v[60:63]
  ds_read_b64 v[96:97], v238 offset:0
  ds_read_b64 v[98:99], v238 offset:32
  ds_read_b64 v[100:101], v238 offset:64
  ds_read_b64 v[102:103], v238 offset:96
  v_mfma_f32_16x16x32_bf16 v[64:67], v[220:223], v[196:199], v[64:67]
  ds_read_b64 v[104:105], v238 offset:128
  ds_read_b64 v[106:107], v238 offset:160
  ds_read_b64 v[108:109], v238 offset:192
  ds_read_b64 v[110:111], v238 offset:224
  v_mfma_f32_16x16x32_bf16 v[68:71], v[220:223], v[200:203], v[68:71]
  ds_read_b64_tr_b16 v[220:221], v233 offset:33056
  ds_read_b64_tr_b16 v[222:223], v233 offset:34080
  ds_read_b128 v[208:211], v235 offset:14336
  s_waitcnt lgkmcnt(15)
  v_mfma_f32_16x16x32_bf16 v[72:75], v[224:227], v[192:195], v[72:75]
  ds_write_b128 v237, v[112:115] offset:0
  ds_write_b128 v237, v[116:119] offset:1088
  ds_write_b128 v237, v[120:123] offset:2176
  ds_write_b128 v237, v[124:127] offset:3264
  v_mfma_f32_16x16x32_bf16 v[76:79], v[224:227], v[196:199], v[76:79]
  v_mfma_f32_16x16x32_bf16 v[80:83], v[224:227], v[200:203], v[80:83]
  ds_read_b64_tr_b16 v[224:225], v233 offset:33088
  ds_read_b64_tr_b16 v[226:227], v233 offset:34112
  ds_read_b128 v[212:215], v235 offset:16384
  v_mfma_f32_16x16x32_bf16 v[84:87], v[228:231], v[192:195], v[84:87]
  ds_read_b64 v[112:113], v238 offset:0
  ds_read_b64 v[114:115], v238 offset:32
  ds_read_b64 v[116:117], v238 offset:64
  ds_read_b64 v[118:119], v238 offset:96
  v_mfma_f32_16x16x32_bf16 v[88:91], v[228:231], v[196:199], v[88:91]
  v_mfma_f32_16x16x32_bf16 v[92:95], v[228:231], v[200:203], v[92:95]
  ds_read_b64_tr_b16 v[228:229], v233 offset:33120
  ds_read_b64_tr_b16 v[230:231], v233 offset:34144
  s_waitcnt lgkmcnt(6)
  v_mfma_f32_16x16x32_bf16 v[0:3], v[216:219], v[204:207], v[0:3]
  ds_read_b64 v[120:121], v238 offset:128
  ds_read_b64 v[122:123], v238 offset:160
  ds_read_b64 v[124:125], v238 offset:192
  ds_read_b64 v[126:127], v238 offset:224
  v_mfma_f32_16x16x32_bf16 v[4:7], v[216:219], v[208:211], v[4:7]
  v_mfma_f32_16x16x32_bf16 v[8:11], v[216:219], v[212:215], v[8:11]
  ds_read_b64_tr_b16 v[216:217], v233 offset:33152
  ds_read_b64_tr_b16 v[218:219], v233 offset:34176
  v_mfma_f32_16x16x32_bf16 v[12:15], v[220:223], v[204:207], v[12:15]
  ds_write_b128 v237, v[128:131] offset:0
  ds_write_b128 v237, v[132:135] offset:1088
  ds_write_b128 v237, v[136:139] offset:2176
  ds_write_b128 v237, v[140:143] offset:3264
  v_mfma_f32_16x16x32_bf16 v[16:19], v[220:223], v[208:211], v[16:19]
  v_mfma_f32_16x16x32_bf16 v[20:23], v[220:223], v[212:215], v[20:23]
  ds_read_b64_tr_b16 v[220:221], v233 offset:33184
  ds_read_b64_tr_b16 v[222:223], v233 offset:34208
  v_mfma_f32_16x16x32_bf16 v[24:27], v[224:227], v[204:207], v[24:27]
  ds_read_b64 v[128:129], v238 offset:0
  ds_read_b64 v[130:131], v238 offset:32
  ds_read_b64 v[132:133], v238 offset:64
  ds_read_b64 v[134:135], v238 offset:96
  v_mfma_f32_16x16x32_bf16 v[28:31], v[224:227], v[208:211], v[28:31]
  v_mfma_f32_16x16x32_bf16 v[32:35], v[224:227], v[212:215], v[32:35]
  ds_read_b64_tr_b16 v[224:225], v233 offset:33216
  ds_read_b64_tr_b16 v[226:227], v233 offset:34240
  s_waitcnt lgkmcnt(15)
  v_mfma_f32_16x16x32_bf16 v[36:39], v[228:231], v[204:207], v[36:39]
  ds_read_b64 v[136:137], v238 offset:128
  ds_read_b64 v[138:139], v238 offset:160
  ds_read_b64 v[140:141], v238 offset:192
  ds_read_b64 v[142:143], v238 offset:224
  v_mfma_f32_16x16x32_bf16 v[40:43], v[228:231], v[208:211], v[40:43]
  v_mfma_f32_16x16x32_bf16 v[44:47], v[228:231], v[212:215], v[44:47]
  s_barrier
  ds_read_b64_tr_b16 v[228:229], v233 offset:33248
  ds_read_b64_tr_b16 v[230:231], v233 offset:34272
  s_waitcnt lgkmcnt(15)
  v_mfma_f32_16x16x32_bf16 v[48:51], v[216:219], v[204:207], v[48:51]
  v_mfma_f32_16x16x32_bf16 v[52:55], v[216:219], v[208:211], v[52:55]
  v_mfma_f32_16x16x32_bf16 v[56:59], v[216:219], v[212:215], v[56:59]
  s_waitcnt lgkmcnt(12)
  v_mfma_f32_16x16x32_bf16 v[60:63], v[220:223], v[204:207], v[60:63]
  v_mfma_f32_16x16x32_bf16 v[64:67], v[220:223], v[208:211], v[64:67]
  v_mfma_f32_16x16x32_bf16 v[68:71], v[220:223], v[212:215], v[68:71]
  s_waitcnt lgkmcnt(6)
  v_mfma_f32_16x16x32_bf16 v[72:75], v[224:227], v[204:207], v[72:75]
  v_mfma_f32_16x16x32_bf16 v[76:79], v[224:227], v[208:211], v[76:79]
  v_mfma_f32_16x16x32_bf16 v[80:83], v[224:227], v[212:215], v[80:83]
  s_waitcnt lgkmcnt(0)
  v_mfma_f32_16x16x32_bf16 v[84:87], v[228:231], v[204:207], v[84:87]
  v_mfma_f32_16x16x32_bf16 v[88:91], v[228:231], v[208:211], v[88:91]
  v_mfma_f32_16x16x32_bf16 v[92:95], v[228:231], v[212:215], v[92:95]
  s_waitcnt lgkmcnt(0)
  s_barrier
  s_cmp_lg_u32 s75, 0
  s_cbranch_scc1 Lkv0_20
  buffer_load_dwordx4 v[176:179], v242, s[32:35], 0 offen offset:0 nt
  buffer_load_dwordx4 v[180:183], v242, s[32:35], 0 offen offset:256 nt
  buffer_load_dwordx4 v[184:187], v242, s[32:35], 0 offen offset:512 nt
  buffer_load_dwordx4 v[188:191], v242, s[32:35], 0 offen offset:768 nt
Lkv0_20:
  s_cmp_lg_u32 s75, 1
  s_cbranch_scc1 Lkv1_20
  buffer_load_dwordx4 v[176:179], v242, s[32:35], 0 offen offset:0 nt
  buffer_load_dwordx4 v[180:183], v242, s[32:35], 0 offen offset:256 nt
  buffer_load_dwordx4 v[184:187], v242, s[32:35], 0 offen offset:512 nt
  buffer_load_dwordx4 v[188:191], v242, s[32:35], 0 offen offset:768 nt
Lkv1_20:
  s_cmp_lg_u32 s75, 2
  s_cbranch_scc1 Lkv2_20
  buffer_load_dwordx4 v[176:179], v242, s[32:35], 0 offen offset:0 nt
  buffer_load_dwordx4 v[180:183], v242, s[32:35], 0 offen offset:256 nt
  buffer_load_dwordx4 v[184:187], v242, s[32:35], 0 offen offset:512 nt
  buffer_load_dwordx4 v[188:191], v242, s[32:35], 0 offen offset:768 nt
Lkv2_20:
  s_cmp_lg_u32 s75, 3
  s_cbranch_scc1 Lkv3_20
  buffer_load_dwordx4 v[176:179], v242, s[32:35], 0 offen offset:0 nt
  buffer_load_dwordx4 v[180:183], v242, s[32:35], 0 offen offset:256 nt
  buffer_load_dwordx4 v[184:187], v242, s[32:35], 0 offen offset:512 nt
  buffer_load_dwordx4 v[188:191], v242, s[32:35], 0 offen offset:768 nt
Lkv3_20:
  s_cmp_lg_u32 s56, 0
  s_cbranch_scc1 Lnoel
  v_mov_b32 v251, 1
  s_mov_b64 exec, 1
  buffer_store_byte v251, v254, s[52:55], s57 offen sc1
  s_mov_b64 exec, -1
Lnoel:
  v_cvt_pk_bf16_f32 v0, v0, v1
  v_cvt_pk_bf16_f32 v1, v2, v3
  v_cvt_pk_bf16_f32 v2, v12, v13
  v_cvt_pk_bf16_f32 v3, v14, v15
  v_cvt_pk_bf16_f32 v24, v24, v25
  v_cvt_pk_bf16_f32 v25, v26, v27
  v_cvt_pk_bf16_f32 v26, v36, v37
  v_cvt_pk_bf16_f32 v27, v38, v39
  v_cvt_pk_bf16_f32 v48, v48, v49
  v_cvt_pk_bf16_f32 v49, v50, v51
  v_cvt_pk_bf16_f32 v50, v60, v61
  v_cvt_pk_bf16_f32 v51, v62, v63
  v_cvt_pk_bf16_f32 v72, v72, v73
  v_cvt_pk_bf16_f32 v73, v74, v75
  v_cvt_pk_bf16_f32 v74, v84, v85
  v_cvt_pk_bf16_f32 v75, v86, v87
  s_waitcnt lgkmcnt(0)
  v_mfma_f32_16x16x32_bf16 v[192:195], v[96:99], v[0:3], 0
  v_cvt_pk_bf16_f32 v4, v4, v5
  v_cvt_pk_bf16_f32 v5, v6, v7
  v_mfma_f32_16x16x32_bf16 v[196:199], v[112:115], v[0:3], 0
  v_cvt_pk_bf16_f32 v6, v16, v17
  v_cvt_pk_bf16_f32 v7, v18, v19
  v_mfma_f32_16x16x32_bf16 v[200:203], v[128:131], v[0:3], 0
  v_cvt_pk_bf16_f32 v28, v28, v29
  v_cvt_pk_bf16_f32 v29, v30, v31
  v_mfma_f32_16x16x32_bf16 v[192:195], v[100:103], v[24:27], v[192:195]
  v_cvt_pk_bf16_f32 v30, v40, v41
  v_cvt_pk_bf16_f32 v31, v42, v43
  v_mfma_f32_16x16x32_bf16 v[196:199], v[116:119], v[24:27], v[196:199]
  v_cvt_pk_bf16_f32 v52, v52, v53
  v_cvt_pk_bf16_f32 v53, v54, v55
  v_mfma_f32_16x16x32_bf16 v[200:203], v[132:135], v[24:27], v[200:203]
  v_cvt_pk_bf16_f32 v54, v64, v65
  v_cvt_pk_bf16_f32 v55, v66, v67
  v_mfma_f32_16x16x32_bf16 v[192:195], v[104:107], v[48:51], v[192:195]
  v_cvt_pk_bf16_f32 v76, v76, v77
  v_cvt_pk_bf16_f32 v77, v78, v79
  v_mfma_f32_16x16x32_bf16 v[196:199], v[120:123], v[48:51], v[196:199]
  v_cvt_pk_bf16_f32 v78, v88, v89
  v_cvt_pk_bf16_f32 v79, v90, v91
  v_mfma_f32_16x16x32_bf16 v[200:203], v[136:139], v[48:51], v[200:203]
  v_mfma_f32_16x16x32_bf16 v[192:195], v[108:111], v[72:75], v[192:195]
  v_mfma_f32_16x16x32_bf16 v[196:199], v[124:127], v[72:75], v[196:199]
  v_mfma_f32_16x16x32_bf16 v[200:203], v[140:143], v[72:75], v[200:203]
  v_mfma_f32_16x16x32_bf16 v[204:207], v[96:99], v[4:7], 0
  v_cvt_pk_bf16_f32 v8, v8, v9
  v_cvt_pk_bf16_f32 v9, v10, v11
  v_mfma_f32_16x16x32_bf16 v[208:211], v[112:115], v[4:7], 0
  v_cvt_pk_bf16_f32 v10, v20, v21
  v_cvt_pk_bf16_f32 v11, v22, v23
  v_mfma_f32_16x16x32_bf16 v[212:215], v[128:131], v[4:7], 0
  v_cvt_pk_bf16_f32 v32, v32, v33
  v_cvt_pk_bf16_f32 v33, v34, v35
  v_mfma_f32_16x16x32_bf16 v[204:207], v[100:103], v[28:31], v[204:207]
  v_cvt_pk_bf16_f32 v34, v44, v45
  v_cvt_pk_bf16_f32 v35, v46, v47
  v_mfma_f32_16x16x32_bf16 v[208:211], v[116:119], v[28:31], v[208:211]
  v_cvt_pk_bf16_f32 v56, v56, v57
  v_cvt_pk_bf16_f32 v57, v58, v59
  v_mfma_f32_16x16x32_bf16 v[212:215], v[132:135], v[28:31], v[212:215]
  v_cvt_pk_bf16_f32 v58, v68, v69
  v_cvt_pk_bf16_f32 v59, v70, v71
  v_mfma_f32_16x16x32_bf16 v[204:207], v[104:107], v[52:55], v[204:207]
  v_cvt_pk_bf16_f32 v80, v80, v81
  v_cvt_pk_bf16_f32 v81, v82, v83
  v_mfma_f32_16x16x32_bf16 v[208:211], v[120:123], v[52:55], v[208:211]
  v_cvt_pk_bf16_f32 v82, v92, v93
  v_cvt_pk_bf16_f32 v83, v94, v95
  v_mfma_f32_16x16x32_bf16 v[212:215], v[136:139], v[52:55], v[212:215]
  v_mfma_f32_16x16x32_bf16 v[204:207], v[108:111], v[76:79], v[204:207]
  v_mfma_f32_16x16x32_bf16 v[208:211], v[124:127], v[76:79], v[208:211]
  v_mfma_f32_16x16x32_bf16 v[212:215], v[140:143], v[76:79], v[212:215]
  v_mfma_f32_16x16x32_bf16 v[216:219], v[96:99], v[8:11], 0
  v_max3_f32 v228, v192, v193, v194
  v_mfma_f32_16x16x32_bf16 v[220:223], v[112:115], v[8:11], 0
  v_max3_f32 v229, v195, v196, v197
  v_mfma_f32_16x16x32_bf16 v[224:227], v[128:131], v[8:11], 0
  v_max3_f32 v228, v228, v198, v199
  v_mfma_f32_16x16x32_bf16 v[216:219], v[100:103], v[32:35], v[216:219]
  v_max3_f32 v229, v229, v200, v201
  v_mfma_f32_16x16x32_bf16 v[220:223], v[116:119], v[32:35], v[220:223]
  v_max3_f32 v228, v228, v202, v203
  v_mfma_f32_16x16x32_bf16 v[224:227], v[132:135], v[32:35], v[224:227]
  v_max_f32 v228, v228, v229
  v_mfma_f32_16x16x32_bf16 v[216:219], v[104:107], v[56:59], v[216:219]
  v_mov_b32 v229, v228
  v_mfma_f32_16x16x32_bf16 v[220:223], v[120:123], v[56:59], v[220:223]
  s_nop 0
  v_permlane32_swap_b32 v228, v229
  v_mfma_f32_16x16x32_bf16 v[224:227], v[136:139], v[56:59], v[224:227]
  v_max_f32 v228, v228, v229
  v_mfma_f32_16x16x32_bf16 v[216:219], v[108:111], v[80:83], v[216:219]
  v_mov_b32 v229, v228
  v_mfma_f32_16x16x32_bf16 v[220:223], v[124:127], v[80:83], v[220:223]
  s_nop 0
  v_permlane16_swap_b32 v228, v229
  v_mfma_f32_16x16x32_bf16 v[224:227], v[140:143], v[80:83], v[224:227]
  v_max_f32 v228, v228, v229
  v_mul_f32 v228, s70, v228
  v_pk_fma_f32 v[192:193], v[192:193], s[70:71], v[228:229] op_sel_hi:[1,0,0] neg_lo:[0,0,1] neg_hi:[0,0,1]
  v_max3_f32 v230, v204, v205, v206
  v_pk_fma_f32 v[194:195], v[194:195], s[70:71], v[228:229] op_sel_hi:[1,0,0] neg_lo:[0,0,1] neg_hi:[0,0,1]
  v_max3_f32 v231, v207, v208, v209
  v_pk_fma_f32 v[196:197], v[196:197], s[70:71], v[228:229] op_sel_hi:[1,0,0] neg_lo:[0,0,1] neg_hi:[0,0,1]
  v_max3_f32 v230, v230, v210, v211
  v_pk_fma_f32 v[198:199], v[198:199], s[70:71], v[228:229] op_sel_hi:[1,0,0] neg_lo:[0,0,1] neg_hi:[0,0,1]
  v_max3_f32 v231, v231, v212, v213
  v_pk_fma_f32 v[200:201], v[200:201], s[70:71], v[228:229] op_sel_hi:[1,0,0] neg_lo:[0,0,1] neg_hi:[0,0,1]
  v_max3_f32 v230, v230, v214, v215
  v_pk_fma_f32 v[202:203], v[202:203], s[70:71], v[228:229] op_sel_hi:[1,0,0] neg_lo:[0,0,1] neg_hi:[0,0,1]
  v_max_f32 v230, v230, v231
  v_exp_f32 v192, v192
  v_mov_b32 v231, v230
  v_exp_f32 v193, v193
  s_nop 0
  v_permlane32_swap_b32 v230, v231
  v_exp_f32 v194, v194
  v_max_f32 v230, v230, v231
  v_exp_f32 v195, v195
  v_mov_b32 v231, v230
  v_exp_f32 v196, v196
  s_nop 0
  v_permlane16_swap_b32 v230, v231
  v_exp_f32 v197, v197
  v_max_f32 v230, v230, v231
  v_exp_f32 v198, v198
  v_mul_f32 v230, s70, v230
  v_exp_f32 v199, v199
  v_exp_f32 v200, v200
  v_exp_f32 v201, v201
  v_exp_f32 v202, v202
  v_exp_f32 v203, v203
  v_pk_add_f32 v[228:229], v[192:193], v[194:195]
  v_pk_add_f32 v[228:229], v[228:229], v[196:197]
  v_pk_add_f32 v[228:229], v[228:229], v[198:199]
  v_pk_add_f32 v[228:229], v[228:229], v[200:201]
  v_pk_add_f32 v[228:229], v[228:229], v[202:203]
  v_add_f32 v228, v228, v229
  v_mov_b32 v229, v228
  s_nop 1
  v_permlane32_swap_b32 v228, v229
  v_add_f32 v228, v228, v229
  v_mov_b32 v229, v228
  s_nop 1
  v_permlane16_swap_b32 v228, v229
  v_add_f32 v228, v228, v229
  v_rcp_f32 v228, v228
  s_nop 0
  v_pk_mul_f32 v[192:193], v[192:193], v[228:229] op_sel_hi:[1,0]
  v_pk_mul_f32 v[194:195], v[194:195], v[228:229] op_sel_hi:[1,0]
  v_pk_mul_f32 v[196:197], v[196:197], v[228:229] op_sel_hi:[1,0]
  v_pk_mul_f32 v[198:199], v[198:199], v[228:229] op_sel_hi:[1,0]
  v_pk_mul_f32 v[200:201], v[200:201], v[228:229] op_sel_hi:[1,0]
  v_pk_mul_f32 v[202:203], v[202:203], v[228:229] op_sel_hi:[1,0]
  v_cvt_pk_bf16_f32 v192, v192, v193
  v_cvt_pk_bf16_f32 v193, v194, v195
  v_cvt_pk_bf16_f32 v194, v196, v197
  v_cvt_pk_bf16_f32 v195, v198, v199
  v_cvt_pk_bf16_f32 v200, v200, v201
  v_cvt_pk_bf16_f32 v201, v202, v203
  s_waitcnt vmcnt(0)
  s_lshl_b32 s73, s14, 7
  s_add_u32 m0, s69, 0
  s_add_u32 s64, s73, 0
  buffer_load_dwordx4 v243, s[40:43], s64 offen lds
  s_add_u32 m0, s69, 1024
  s_add_u32 s64, s73, 8192
  buffer_load_dwordx4 v243, s[40:43], s64 offen lds
  s_add_u32 m0, s69, 2048
  s_add_u32 s64, s73, 16384
  buffer_load_dwordx4 v243, s[40:43], s64 offen lds
  s_add_u32 m0, s69, 3072
  s_add_u32 s64, s73, 24576
  buffer_load_dwordx4 v243, s[40:43], s64 offen lds
  s_lshl_b32 s73, s14, 7
  s_add_u32 m0, s69, 32768
  s_add_u32 s64, s73, 262144
  buffer_load_dwordx4 v243, s[40:43], s64 offen lds
  s_add_u32 m0, s69, 33792
  s_add_u32 s64, s73, 270336
  buffer_load_dwordx4 v243, s[40:43], s64 offen lds
  s_add_u32 m0, s69, 34816
  s_add_u32 s64, s73, 278528
  buffer_load_dwordx4 v243, s[40:43], s64 offen lds
  s_add_u32 m0, s69, 35840
  s_add_u32 s64, s73, 286720
  buffer_load_dwordx4 v243, s[40:43], s64 offen lds
  v_perm_b32 v96, v148, v144, s71
  v_pk_fma_f32 v[204:205], v[204:205], s[70:71], v[230:231] op_sel_hi:[1,0,0] neg_lo:[0,0,1] neg_hi:[0,0,1]
  v_perm_b32 v97, v156, v152, s71
  v_pk_fma_f32 v[206:207], v[206:207], s[70:71], v[230:231] op_sel_hi:[1,0,0] neg_lo:[0,0,1] neg_hi:[0,0,1]
  v_perm_b32 v98, v164, v160, s71
  v_pk_fma_f32 v[208:209], v[208:209], s[70:71], v[230:231] op_sel_hi:[1,0,0] neg_lo:[0,0,1] neg_hi:[0,0,1]
  v_perm_b32 v99, v172, v168, s71
  v_pk_fma_f32 v[210:211], v[210:211], s[70:71], v[230:231] op_sel_hi:[1,0,0] neg_lo:[0,0,1] neg_hi:[0,0,1]
  v_perm_b32 v100, v148, v144, s72
  v_pk_fma_f32 v[212:213], v[212:213], s[70:71], v[230:231] op_sel_hi:[1,0,0] neg_lo:[0,0,1] neg_hi:[0,0,1]
  v_perm_b32 v101, v156, v152, s72
  v_pk_fma_f32 v[214:215], v[214:215], s[70:71], v[230:231] op_sel_hi:[1,0,0] neg_lo:[0,0,1] neg_hi:[0,0,1]
  v_perm_b32 v102, v164, v160, s72
  v_exp_f32 v204, v204
  v_perm_b32 v103, v172, v168, s72
  v_exp_f32 v205, v205
  v_perm_b32 v104, v149, v145, s71
  v_exp_f32 v206, v206
  v_perm_b32 v105, v157, v153, s71
  v_exp_f32 v207, v207
  v_perm_b32 v106, v165, v161, s71
  v_exp_f32 v208, v208
  v_perm_b32 v107, v173, v169, s71
  v_exp_f32 v209, v209
  v_perm_b32 v108, v149, v145, s72
  v_exp_f32 v210, v210
  v_perm_b32 v109, v157, v153, s72
  v_exp_f32 v211, v211
  v_perm_b32 v110, v165, v161, s72
  v_exp_f32 v212, v212
  v_perm_b32 v111, v173, v169, s72
  v_exp_f32 v213, v213
  v_perm_b32 v112, v150, v146, s71
  v_exp_f32 v214, v214
  v_perm_b32 v113, v158, v154, s71
  v_exp_f32 v215, v215
  v_perm_b32 v114, v166, v162, s71
  v_pk_add_f32 v[230:231], v[204:205], v[206:207]
  v_perm_b32 v115, v174, v170, s71
  v_pk_add_f32 v[230:231], v[230:231], v[208:209]
  v_perm_b32 v116, v150, v146, s72
  v_pk_add_f32 v[230:231], v[230:231], v[210:211]
  v_perm_b32 v117, v158, v154, s72
  v_pk_add_f32 v[230:231], v[230:231], v[212:213]
  v_perm_b32 v118, v166, v162, s72
  v_pk_add_f32 v[230:231], v[230:231], v[214:215]
  v_perm_b32 v119, v174, v170, s72
  v_add_f32 v230, v230, v231
  v_perm_b32 v120, v151, v147, s71
  v_perm_b32 v121, v159, v155, s71
  v_perm_b32 v122, v167, v163, s71
  v_perm_b32 v123, v175, v171, s71
  v_perm_b32 v124, v151, v147, s72
  v_perm_b32 v125, v159, v155, s72
  v_perm_b32 v126, v167, v163, s72
  v_perm_b32 v127, v175, v171, s72
  v_perm_b32 v128, v180, v176, s71
  v_perm_b32 v129, v188, v184, s71
  v_perm_b32 v130, v180, v176, s72
  v_perm_b32 v131, v188, v184, s72
  v_perm_b32 v132, v181, v177, s71
  v_perm_b32 v133, v189, v185, s71
  v_perm_b32 v134, v181, v177, s72
  v_perm_b32 v135, v189, v185, s72
  v_perm_b32 v136, v182, v178, s71
  v_perm_b32 v137, v190, v186, s71
  v_perm_b32 v138, v182, v178, s72
  v_perm_b32 v139, v190, v186, s72
  v_perm_b32 v140, v183, v179, s71
  v_perm_b32 v141, v191, v187, s71
  v_perm_b32 v142, v183, v179, s72
  v_perm_b32 v143, v191, v187, s72
  v_mfma_f32_16x16x32_bf16 v[0:3], v[96:99], v[192:195], 0
  v_mov_b32 v231, v230
  v_max3_f32 v232, v216, v217, v218
  s_nop 0
  v_permlane32_swap_b32 v230, v231
  v_mfma_f32_16x16x32_bf16 v[12:15], v[100:103], v[192:195], 0
  v_max3_f32 v233, v219, v220, v221
  v_add_f32 v230, v230, v231
  v_max3_f32 v232, v232, v222, v223
  v_mfma_f32_16x16x32_bf16 v[24:27], v[104:107], v[192:195], 0
  v_mov_b32 v231, v230
  v_max3_f32 v233, v233, v224, v225
  s_nop 0
  v_permlane16_swap_b32 v230, v231
  v_mfma_f32_16x16x32_bf16 v[36:39], v[108:111], v[192:195], 0
  v_max3_f32 v232, v232, v226, v227
  v_add_f32 v230, v230, v231
  v_max_f32 v232, v232, v233
  v_mfma_f32_16x16x32_bf16 v[48:51], v[112:115], v[192:195], 0
  v_rcp_f32 v230, v230
  v_mov_b32 v233, v232
  v_pk_mul_f32 v[204:205], v[204:205], v[230:231] op_sel_hi:[1,0]
  v_mfma_f32_16x16x32_bf16 v[60:63], v[116:119], v[192:195], 0
  v_permlane32_swap_b32 v232, v233
  v_pk_mul_f32 v[206:207], v[206:207], v[230:231] op_sel_hi:[1,0]
  v_max_f32 v232, v232, v233
  v_mfma_f32_16x16x32_bf16 v[72:75], v[120:123], v[192:195], 0
  v_pk_mul_f32 v[208:209], v[208:209], v[230:231] op_sel_hi:[1,0]
  v_mov_b32 v233, v232
  v_pk_mul_f32 v[210:211], v[210:211], v[230:231] op_sel_hi:[1,0]
  v_mfma_f32_16x16x32_bf16 v[84:87], v[124:127], v[192:195], 0
  v_permlane16_swap_b32 v232, v233
  v_pk_mul_f32 v[212:213], v[212:213], v[230:231] op_sel_hi:[1,0]
  v_max_f32 v232, v232, v233
  v_mfma_f32_16x16x16_bf16 v[0:3], v[128:129], v[200:201], v[0:3]
  v_pk_mul_f32 v[214:215], v[214:215], v[230:231] op_sel_hi:[1,0]
  v_mul_f32 v232, s70, v232
  v_cvt_pk_bf16_f32 v204, v204, v205
  v_mfma_f32_16x16x16_bf16 v[12:15], v[130:131], v[200:201], v[12:15]
  v_pk_fma_f32 v[216:217], v[216:217], s[70:71], v[232:233] op_sel_hi:[1,0,0] neg_lo:[0,0,1] neg_hi:[0,0,1]
  v_cvt_pk_bf16_f32 v205, v206, v207
  v_pk_fma_f32 v[218:219], v[218:219], s[70:71], v[232:233] op_sel_hi:[1,0,0] neg_lo:[0,0,1] neg_hi:[0,0,1]
  v_mfma_f32_16x16x16_bf16 v[24:27], v[132:133], v[200:201], v[24:27]
  v_cvt_pk_bf16_f32 v206, v208, v209
  v_pk_fma_f32 v[220:221], v[220:221], s[70:71], v[232:233] op_sel_hi:[1,0,0] neg_lo:[0,0,1] neg_hi:[0,0,1]
  v_cvt_pk_bf16_f32 v207, v210, v211
  v_mfma_f32_16x16x16_bf16 v[36:39], v[134:135], v[200:201], v[36:39]
  v_pk_fma_f32 v[222:223], v[222:223], s[70:71], v[232:233] op_sel_hi:[1,0,0] neg_lo:[0,0,1] neg_hi:[0,0,1]
  v_cvt_pk_bf16_f32 v212, v212, v213
  v_pk_fma_f32 v[224:225], v[224:225], s[70:71], v[232:233] op_sel_hi:[1,0,0] neg_lo:[0,0,1] neg_hi:[0,0,1]
  v_mfma_f32_16x16x16_bf16 v[48:51], v[136:137], v[200:201], v[48:51]
  v_cvt_pk_bf16_f32 v213, v214, v215
  v_pk_fma_f32 v[226:227], v[226:227], s[70:71], v[232:233] op_sel_hi:[1,0,0] neg_lo:[0,0,1] neg_hi:[0,0,1]
  v_exp_f32 v216, v216
  v_mfma_f32_16x16x16_bf16 v[60:63], v[138:139], v[200:201], v[60:63]
  v_exp_f32 v217, v217
  v_exp_f32 v218, v218
  v_exp_f32 v219, v219
  v_mfma_f32_16x16x16_bf16 v[72:75], v[140:141], v[200:201], v[72:75]
  v_exp_f32 v220, v220
  v_exp_f32 v221, v221
  v_mfma_f32_16x16x16_bf16 v[84:87], v[142:143], v[200:201], v[84:87]
  v_exp_f32 v222, v222
  v_exp_f32 v223, v223
  v_exp_f32 v224, v224
  v_exp_f32 v225, v225
  v_exp_f32 v226, v226
  v_exp_f32 v227, v227
  v_pk_add_f32 v[232:233], v[216:217], v[218:219]
  v_pk_add_f32 v[232:233], v[232:233], v[220:221]
  v_pk_add_f32 v[232:233], v[232:233], v[222:223]
  v_pk_add_f32 v[232:233], v[232:233], v[224:225]
  v_pk_add_f32 v[232:233], v[232:233], v[226:227]
  v_add_f32 v232, v232, v233
  v_mfma_f32_16x16x32_bf16 v[4:7], v[96:99], v[204:207], 0
  v_mov_b32 v233, v232
  s_nop 1
  v_permlane32_swap_b32 v232, v233
  v_add_f32 v232, v232, v233
  v_mfma_f32_16x16x32_bf16 v[16:19], v[100:103], v[204:207], 0
  v_mov_b32 v233, v232
  s_nop 1
  v_permlane16_swap_b32 v232, v233
  v_add_f32 v232, v232, v233
  v_mfma_f32_16x16x32_bf16 v[28:31], v[104:107], v[204:207], 0
  v_rcp_f32 v232, v232
  s_nop 0
  v_pk_mul_f32 v[216:217], v[216:217], v[232:233] op_sel_hi:[1,0]
  v_pk_mul_f32 v[218:219], v[218:219], v[232:233] op_sel_hi:[1,0]
  v_mfma_f32_16x16x32_bf16 v[40:43], v[108:111], v[204:207], 0
  v_pk_mul_f32 v[220:221], v[220:221], v[232:233] op_sel_hi:[1,0]
  v_pk_mul_f32 v[222:223], v[222:223], v[232:233] op_sel_hi:[1,0]
  v_pk_mul_f32 v[224:225], v[224:225], v[232:233] op_sel_hi:[1,0]
  v_mfma_f32_16x16x32_bf16 v[52:55], v[112:115], v[204:207], 0
  v_pk_mul_f32 v[226:227], v[226:227], v[232:233] op_sel_hi:[1,0]
  v_cvt_pk_bf16_f32 v216, v216, v217
  v_cvt_pk_bf16_f32 v217, v218, v219
  v_mfma_f32_16x16x32_bf16 v[64:67], v[116:119], v[204:207], 0
  v_cvt_pk_bf16_f32 v218, v220, v221
  v_cvt_pk_bf16_f32 v219, v222, v223
  v_cvt_pk_bf16_f32 v224, v224, v225
  v_mfma_f32_16x16x32_bf16 v[76:79], v[120:123], v[204:207], 0
  v_cvt_pk_bf16_f32 v225, v226, v227
  v_cvt_pk_bf16_f32 v144, v0, v12
  v_cvt_pk_bf16_f32 v145, v24, v36
  v_mfma_f32_16x16x32_bf16 v[88:91], v[124:127], v[204:207], 0
  v_cvt_pk_bf16_f32 v146, v48, v60
  v_cvt_pk_bf16_f32 v147, v72, v84
  ds_write_b128 v255, v[144:147] offset:0
  v_mfma_f32_16x16x16_bf16 v[4:7], v[128:129], v[212:213], v[4:7]
  v_cvt_pk_bf16_f32 v156, v1, v13
  v_cvt_pk_bf16_f32 v157, v25, v37
  v_cvt_pk_bf16_f32 v158, v49, v61
  v_mfma_f32_16x16x16_bf16 v[16:19], v[130:131], v[212:213], v[16:19]
  v_cvt_pk_bf16_f32 v159, v73, v85
  ds_write_b128 v255, v[156:159] offset:3072
  v_mfma_f32_16x16x16_bf16 v[28:31], v[132:133], v[212:213], v[28:31]
  v_mfma_f32_16x16x16_bf16 v[40:43], v[134:135], v[212:213], v[40:43]
  v_mfma_f32_16x16x16_bf16 v[52:55], v[136:137], v[212:213], v[52:55]
  v_mfma_f32_16x16x16_bf16 v[64:67], v[138:139], v[212:213], v[64:67]
  v_mfma_f32_16x16x16_bf16 v[76:79], v[140:141], v[212:213], v[76:79]
  v_mfma_f32_16x16x16_bf16 v[88:91], v[142:143], v[212:213], v[88:91]
  v_cvt_pk_bf16_f32 v168, v2, v14
  v_cvt_pk_bf16_f32 v169, v26, v38
  v_cvt_pk_bf16_f32 v170, v50, v62
  v_cvt_pk_bf16_f32 v171, v74, v86
  ds_write_b128 v255, v[168:171] offset:6144
  v_cvt_pk_bf16_f32 v180, v3, v15
  v_cvt_pk_bf16_f32 v181, v27, v39
  v_cvt_pk_bf16_f32 v182, v51, v63
  v_cvt_pk_bf16_f32 v183, v75, v87
  ds_write_b128 v255, v[180:183] offset:9216
  v_mfma_f32_16x16x32_bf16 v[8:11], v[96:99], v[216:219], 0
  v_cvt_pk_bf16_f32 v148, v4, v16
  v_cvt_pk_bf16_f32 v149, v28, v40
  v_mfma_f32_16x16x32_bf16 v[20:23], v[100:103], v[216:219], 0
  v_cvt_pk_bf16_f32 v150, v52, v64
  v_cvt_pk_bf16_f32 v151, v76, v88
  v_mfma_f32_16x16x32_bf16 v[32:35], v[104:107], v[216:219], 0
  ds_write_b128 v255, v[148:151] offset:1024
  v_cvt_pk_bf16_f32 v160, v5, v17
  v_mfma_f32_16x16x32_bf16 v[44:47], v[108:111], v[216:219], 0
  v_cvt_pk_bf16_f32 v161, v29, v41
  v_cvt_pk_bf16_f32 v162, v53, v65
  v_mfma_f32_16x16x32_bf16 v[56:59], v[112:115], v[216:219], 0
  v_cvt_pk_bf16_f32 v163, v77, v89
  ds_write_b128 v255, v[160:163] offset:4096
  v_mfma_f32_16x16x32_bf16 v[68:71], v[116:119], v[216:219], 0
  v_cvt_pk_bf16_f32 v172, v6, v18
  v_cvt_pk_bf16_f32 v173, v30, v42
  v_mfma_f32_16x16x32_bf16 v[80:83], v[120:123], v[216:219], 0
  v_cvt_pk_bf16_f32 v174, v54, v66
  v_cvt_pk_bf16_f32 v175, v78, v90
  v_mfma_f32_16x16x32_bf16 v[92:95], v[124:127], v[216:219], 0
  ds_write_b128 v255, v[172:175] offset:7168
  v_cvt_pk_bf16_f32 v184, v7, v19
  v_mfma_f32_16x16x16_bf16 v[8:11], v[128:129], v[224:225], v[8:11]
  v_cvt_pk_bf16_f32 v185, v31, v43
  v_cvt_pk_bf16_f32 v186, v55, v67
  v_mfma_f32_16x16x16_bf16 v[20:23], v[130:131], v[224:225], v[20:23]
  v_cvt_pk_bf16_f32 v187, v79, v91
  ds_write_b128 v255, v[184:187] offset:10240
  v_mfma_f32_16x16x16_bf16 v[32:35], v[132:133], v[224:225], v[32:35]
  v_mfma_f32_16x16x16_bf16 v[44:47], v[134:135], v[224:225], v[44:47]
  v_mfma_f32_16x16x16_bf16 v[56:59], v[136:137], v[224:225], v[56:59]
  v_mfma_f32_16x16x16_bf16 v[68:71], v[138:139], v[224:225], v[68:71]
  v_mfma_f32_16x16x16_bf16 v[80:83], v[140:141], v[224:225], v[80:83]
  v_mfma_f32_16x16x16_bf16 v[92:95], v[142:143], v[224:225], v[92:95]
  v_cvt_pk_bf16_f32 v152, v8, v20
  s_nop 2
  v_cvt_pk_bf16_f32 v153, v32, v44
  s_nop 0
  v_cvt_pk_bf16_f32 v154, v56, v68
  s_nop 0
  v_cvt_pk_bf16_f32 v155, v80, v92
  ds_write_b128 v255, v[152:155] offset:2048
  v_cvt_pk_bf16_f32 v164, v9, v21
  v_cvt_pk_bf16_f32 v165, v33, v45
  v_cvt_pk_bf16_f32 v166, v57, v69
  v_cvt_pk_bf16_f32 v167, v81, v93
  ds_write_b128 v255, v[164:167] offset:5120
  v_cvt_pk_bf16_f32 v176, v10, v22
  v_cvt_pk_bf16_f32 v177, v34, v46
  v_cvt_pk_bf16_f32 v178, v58, v70
  v_cvt_pk_bf16_f32 v179, v82, v94
  ds_write_b128 v255, v[176:179] offset:8192
  v_cvt_pk_bf16_f32 v188, v11, v23
  v_cvt_pk_bf16_f32 v189, v35, v47
  v_cvt_pk_bf16_f32 v190, v59, v71
  v_cvt_pk_bf16_f32 v191, v83, v95
  ds_write_b128 v255, v[188:191] offset:11264
  buffer_load_dwordx2 v[250:251], v254, s[52:55], 0 offen sc1
  s_mul_i32 s64, s61, 12288
  s_add_u32 s64, s64, 65536
  v_add_u32 v234, s64, v247
  v_add_u32 v235, 49152, v234
  v_mov_b32 v249, 1
  s_waitcnt vmcnt(1) lgkmcnt(0)
  s_barrier
  v_lshrrev_b32 v253, 1, v247
  ds_read_b128 v[0:3], v234 offset:0
  ds_read_b128 v[4:7], v234 offset:1024
  ds_read_b128 v[8:11], v234 offset:2048
  ds_read_b128 v[12:15], v234 offset:3072
  ds_read_b128 v[16:19], v234 offset:4096
  ds_read_b128 v[20:23], v234 offset:5120
  ds_read_b128 v[24:27], v234 offset:6144
  ds_read_b128 v[28:31], v234 offset:7168
  ds_read_b128 v[32:35], v234 offset:8192
  ds_read_b128 v[36:39], v234 offset:9216
  ds_read_b128 v[40:43], v234 offset:10240
  ds_read_b128 v[44:47], v234 offset:11264
  ds_read_b128 v[48:51], v234 offset:24576
  ds_read_b128 v[52:55], v234 offset:25600
  ds_read_b128 v[56:59], v234 offset:26624
  ds_read_b128 v[60:63], v234 offset:27648
  ds_read_b128 v[64:67], v234 offset:28672
  ds_read_b128 v[68:71], v234 offset:29696
  ds_read_b128 v[72:75], v234 offset:30720
  ds_read_b128 v[76:79], v234 offset:31744
  ds_read_b128 v[80:83], v234 offset:32768
  ds_read_b128 v[84:87], v234 offset:33792
  ds_read_b128 v[88:91], v234 offset:34816
  ds_read_b128 v[92:95], v234 offset:35840
  ds_read_b64_tr_b16 v[216:217], v244 offset:0
  ds_read_b64_tr_b16 v[218:219], v244 offset:512
  ds_read_b64_tr_b16 v[220:221], v244 offset:1024
  ds_read_b64_tr_b16 v[222:223], v244 offset:1536
  ds_read_b64_tr_b16 v[224:225], v244 offset:2048
  ds_read_b64_tr_b16 v[226:227], v244 offset:2560
  s_waitcnt lgkmcnt(6)
  s_barrier
  s_lshl_b32 s73, s15, 7
  s_add_u32 m0, s69, 65536
  s_add_u32 s64, s73, 0
  buffer_load_dwordx4 v243, s[40:43], s64 offen lds
  s_add_u32 m0, s69, 66560
  s_add_u32 s64, s73, 8192
  buffer_load_dwordx4 v243, s[40:43], s64 offen lds
  s_add_u32 m0, s69, 67584
  s_add_u32 s64, s73, 16384
  buffer_load_dwordx4 v243, s[40:43], s64 offen lds
  s_add_u32 m0, s69, 68608
  s_add_u32 s64, s73, 24576
  buffer_load_dwordx4 v243, s[40:43], s64 offen lds
  s_mov_b32 s3, 0
  s_lshl_b32 s13, s57, 7
  s_add_u32 s13, s13, s23
  ds_read_b64_tr_b16 v[228:229], v244 offset:3072
  ds_read_b64_tr_b16 v[230:231], v244 offset:3584
  ds_read_b128 v[96:99], v235 offset:0
  ds_read_b128 v[100:103], v235 offset:1024
  ds_read_b128 v[104:107], v235 offset:2048
  ds_read_b128 v[108:111], v235 offset:3072
  ds_read_b128 v[112:115], v235 offset:4096
  s_waitcnt lgkmcnt(11)
  v_mfma_f32_16x16x32_bf16 v[192:195], v[216:219], v[0:3], 0
  v_mfma_f32_16x16x32_bf16 v[196:199], v[216:219], v[4:7], 0
  v_mfma_f32_16x16x32_bf16 v[200:203], v[216:219], v[8:11], 0
  ds_read_b64_tr_b16 v[216:217], v244 offset:16384
  ds_read_b64_tr_b16 v[218:219], v244 offset:16896
  ds_read_b128 v[116:119], v235 offset:5120
  ds_read_b128 v[120:123], v235 offset:6144
  ds_read_b128 v[124:127], v235 offset:7168
  ds_read_b128 v[128:131], v235 offset:8192
  ds_read_b128 v[132:135], v235 offset:9216
  s_waitcnt lgkmcnt(15)
  v_mfma_f32_16x16x32_bf16 v[192:195], v[220:223], v[12:15], v[192:195]
  v_mfma_f32_16x16x32_bf16 v[196:199], v[220:223], v[16:19], v[196:199]
  v_mfma_f32_16x16x32_bf16 v[200:203], v[220:223], v[20:23], v[200:203]
  ds_read_b64_tr_b16 v[220:221], v244 offset:17408
  ds_read_b64_tr_b16 v[222:223], v244 offset:17920
  ds_read_b128 v[136:139], v235 offset:10240
  ds_read_b128 v[140:143], v235 offset:11264
  ds_read_b128 v[144:147], v235 offset:24576
  ds_read_b128 v[148:151], v235 offset:25600
  ds_read_b128 v[152:155], v235 offset:26624
  s_waitcnt lgkmcnt(15)
  v_mfma_f32_16x16x32_bf16 v[192:195], v[224:227], v[24:27], v[192:195]
  v_mfma_f32_16x16x32_bf16 v[196:199], v[224:227], v[28:31], v[196:199]
  v_mfma_f32_16x16x32_bf16 v[200:203], v[224:227], v[32:35], v[200:203]
  ds_read_b64_tr_b16 v[224:225], v244 offset:18432
  ds_read_b64_tr_b16 v[226:227], v244 offset:18944
  ds_read_b128 v[156:159], v235 offset:27648
  ds_read_b128 v[160:163], v235 offset:28672
  ds_read_b128 v[164:167], v235 offset:29696
  ds_read_b128 v[168:171], v235 offset:30720
  ds_read_b128 v[172:175], v235 offset:31744
  v_mfma_f32_16x16x32_bf16 v[192:195], v[228:231], v[36:39], v[192:195]
  v_mfma_f32_16x16x32_bf16 v[196:199], v[228:231], v[40:43], v[196:199]
  v_mfma_f32_16x16x32_bf16 v[200:203], v[228:231], v[44:47], v[200:203]
  ds_read_b64_tr_b16 v[228:229], v244 offset:19456
  ds_read_b64_tr_b16 v[230:231], v244 offset:19968
  ds_read_b128 v[176:179], v235 offset:32768
  ds_read_b128 v[180:183], v235 offset:33792
  ds_read_b128 v[184:187], v235 offset:34816
  ds_read_b128 v[188:191], v235 offset:35840
  s_waitcnt lgkmcnt(15)
  v_mfma_f32_16x16x32_bf16 v[192:195], v[216:219], v[48:51], v[192:195]
  v_mfma_f32_16x16x32_bf16 v[196:199], v[216:219], v[52:55], v[196:199]
  v_mfma_f32_16x16x32_bf16 v[200:203], v[216:219], v[56:59], v[200:203]
  s_waitcnt lgkmcnt(0)
  s_barrier
  s_lshl_b32 s73, s15, 7
  s_add_u32 m0, s69, 98304
  s_add_u32 s64, s73, 262144
  buffer_load_dwordx4 v243, s[40:43], s64 offen lds
  s_add_u32 m0, s69, 99328
  s_add_u32 s64, s73, 270336
  buffer_load_dwordx4 v243, s[40:43], s64 offen lds
  s_add_u32 m0, s69, 100352
  s_add_u32 s64, s73, 278528
  buffer_load_dwordx4 v243, s[40:43], s64 offen lds
  s_add_u32 m0, s69, 101376
  s_add_u32 s64, s73, 286720
  buffer_load_dwordx4 v243, s[40:43], s64 offen lds
  ds_read_b64_tr_b16 v[216:217], v244 offset:32768
  ds_read_b64_tr_b16 v[218:219], v244 offset:33280
  v_mfma_f32_16x16x32_bf16 v[192:195], v[220:223], v[60:63], v[192:195]
  s_lshl_b32 s73, s16, 7
  s_add_u32 m0, s69, 131072
  s_add_u32 s64, s73, 0
  buffer_load_dwordx4 v243, s[40:43], s64 offen lds
  v_mfma_f32_16x16x32_bf16 v[196:199], v[220:223], v[64:67], v[196:199]
  v_mfma_f32_16x16x32_bf16 v[200:203], v[220:223], v[68:71], v[200:203]
  ds_read_b64_tr_b16 v[220:221], v244 offset:33792
  ds_read_b64_tr_b16 v[222:223], v244 offset:34304
  v_mfma_f32_16x16x32_bf16 v[192:195], v[224:227], v[72:75], v[192:195]
  s_add_u32 m0, s69, 132096
  s_add_u32 s64, s73, 8192
  buffer_load_dwordx4 v243, s[40:43], s64 offen lds
  v_mfma_f32_16x16x32_bf16 v[196:199], v[224:227], v[76:79], v[196:199]
  v_mfma_f32_16x16x32_bf16 v[200:203], v[224:227], v[80:83], v[200:203]
  ds_read_b64_tr_b16 v[224:225], v244 offset:34816
  ds_read_b64_tr_b16 v[226:227], v244 offset:35328
  v_mfma_f32_16x16x32_bf16 v[192:195], v[228:231], v[84:87], v[192:195]
  s_add_u32 m0, s69, 133120
  s_add_u32 s64, s73, 16384
  buffer_load_dwordx4 v243, s[40:43], s64 offen lds
  v_mfma_f32_16x16x32_bf16 v[196:199], v[228:231], v[88:91], v[196:199]
  v_mfma_f32_16x16x32_bf16 v[200:203], v[228:231], v[92:95], v[200:203]
  ds_read_b64_tr_b16 v[228:229], v244 offset:35840
  ds_read_b64_tr_b16 v[230:231], v244 offset:36352
  s_waitcnt lgkmcnt(6)
  v_mfma_f32_16x16x32_bf16 v[192:195], v[216:219], v[96:99], v[192:195]
  s_add_u32 m0, s69, 134144
  s_add_u32 s64, s73, 24576
  buffer_load_dwordx4 v243, s[40:43], s64 offen lds
  v_mfma_f32_16x16x32_bf16 v[196:199], v[216:219], v[100:103], v[196:199]
  v_mfma_f32_16x16x32_bf16 v[200:203], v[216:219], v[104:107], v[200:203]
  ds_read_b64_tr_b16 v[216:217], v244 offset:49152
  ds_read_b64_tr_b16 v[218:219], v244 offset:49664
  s_waitcnt lgkmcnt(6)
  v_mfma_f32_16x16x32_bf16 v[192:195], v[220:223], v[108:111], v[192:195]
  v_mfma_f32_16x16x32_bf16 v[196:199], v[220:223], v[112:115], v[196:199]
  v_mfma_f32_16x16x32_bf16 v[200:203], v[220:223], v[116:119], v[200:203]
  ds_read_b64_tr_b16 v[220:221], v244 offset:50176
  ds_read_b64_tr_b16 v[222:223], v244 offset:50688
  s_waitcnt lgkmcnt(6)
  v_mfma_f32_16x16x32_bf16 v[192:195], v[224:227], v[120:123], v[192:195]
  v_mfma_f32_16x16x32_bf16 v[196:199], v[224:227], v[124:127], v[196:199]
  v_mfma_f32_16x16x32_bf16 v[200:203], v[224:227], v[128:131], v[200:203]
  ds_read_b64_tr_b16 v[224:225], v244 offset:51200
  ds_read_b64_tr_b16 v[226:227], v244 offset:51712
  s_waitcnt lgkmcnt(6)
  v_mfma_f32_16x16x32_bf16 v[192:195], v[228:231], v[132:135], v[192:195]
  v_mfma_f32_16x16x32_bf16 v[196:199], v[228:231], v[136:139], v[196:199]
  v_mfma_f32_16x16x32_bf16 v[200:203], v[228:231], v[140:143], v[200:203]
  ds_read_b64_tr_b16 v[228:229], v244 offset:52224
  ds_read_b64_tr_b16 v[230:231], v244 offset:52736
  s_waitcnt lgkmcnt(6)
  v_mfma_f32_16x16x32_bf16 v[192:195], v[216:219], v[144:147], v[192:195]
  v_mfma_f32_16x16x32_bf16 v[196:199], v[216:219], v[148:151], v[196:199]
  v_mfma_f32_16x16x32_bf16 v[200:203], v[216:219], v[152:155], v[200:203]
  s_waitcnt vmcnt(8)
  s_barrier
  ds_read_b64_tr_b16 v[216:217], v245 offset:0
  ds_read_b64_tr_b16 v[218:219], v245 offset:512
  s_waitcnt lgkmcnt(6)
  v_mfma_f32_16x16x32_bf16 v[192:195], v[220:223], v[156:159], v[192:195]
  s_lshl_b32 s73, s16, 7
  s_add_u32 m0, s69, 0
  s_add_u32 s64, s73, 262144
  buffer_load_dwordx4 v243, s[40:43], s64 offen lds
  v_mfma_f32_16x16x32_bf16 v[196:199], v[220:223], v[160:163], v[196:199]
  v_mfma_f32_16x16x32_bf16 v[200:203], v[220:223], v[164:167], v[200:203]
  ds_read_b64_tr_b16 v[220:221], v245 offset:1024
  ds_read_b64_tr_b16 v[222:223], v245 offset:1536
  s_waitcnt lgkmcnt(6)
  v_mfma_f32_16x16x32_bf16 v[192:195], v[224:227], v[168:171], v[192:195]
  s_add_u32 m0, s69, 1024
  s_add_u32 s64, s73, 270336
  buffer_load_dwordx4 v243, s[40:43], s64 offen lds
  v_mfma_f32_16x16x32_bf16 v[196:199], v[224:227], v[172:175], v[196:199]
  v_mfma_f32_16x16x32_bf16 v[200:203], v[224:227], v[176:179], v[200:203]
  ds_read_b64_tr_b16 v[224:225], v245 offset:2048
  ds_read_b64_tr_b16 v[226:227], v245 offset:2560
  s_waitcnt lgkmcnt(6)
  v_mfma_f32_16x16x32_bf16 v[192:195], v[228:231], v[180:183], v[192:195]
  s_add_u32 m0, s69, 2048
  s_add_u32 s64, s73, 278528
  buffer_load_dwordx4 v243, s[40:43], s64 offen lds
  v_mfma_f32_16x16x32_bf16 v[196:199], v[228:231], v[184:187], v[196:199]
  v_mfma_f32_16x16x32_bf16 v[200:203], v[228:231], v[188:191], v[200:203]
  ds_read_b64_tr_b16 v[228:229], v245 offset:3072
  ds_read_b64_tr_b16 v[230:231], v245 offset:3584
  s_waitcnt lgkmcnt(6)
  v_mfma_f32_16x16x32_bf16 v[204:207], v[216:219], v[0:3], 0
  s_add_u32 m0, s69, 3072
  s_add_u32 s64, s73, 286720
  buffer_load_dwordx4 v243, s[40:43], s64 offen lds
  v_mfma_f32_16x16x32_bf16 v[208:211], v[216:219], v[4:7], 0
  v_mfma_f32_16x16x32_bf16 v[212:215], v[216:219], v[8:11], 0
  ds_read_b64_tr_b16 v[216:217], v245 offset:16384
  ds_read_b64_tr_b16 v[218:219], v245 offset:16896
  s_waitcnt lgkmcnt(6)
  v_mfma_f32_16x16x32_bf16 v[204:207], v[220:223], v[12:15], v[204:207]
  v_cvt_pk_bf16_f32 v234, v192, v193
  v_cvt_pk_bf16_f32 v235, v194, v195
  v_cvt_pk_bf16_f32 v236, v196, v197
  v_cvt_pk_bf16_f32 v237, v198, v199
  v_cvt_pk_bf16_f32 v238, v200, v201
  v_cvt_pk_bf16_f32 v239, v202, v203
  s_mul_i32 s65, s14, 98304
  s_add_u32 s65, s65, s22
  buffer_store_dwordx4 v[234:237], v247, s[48:51], s65 offen sc1
  buffer_store_dwordx2 v[238:239], v253, s[48:51], s65 offen offset:1024 sc1
  v_mfma_f32_16x16x32_bf16 v[208:211], v[220:223], v[16:19], v[208:211]
  v_mfma_f32_16x16x32_bf16 v[212:215], v[220:223], v[20:23], v[212:215]
  ds_read_b64_tr_b16 v[220:221], v245 offset:17408
  ds_read_b64_tr_b16 v[222:223], v245 offset:17920
  s_waitcnt lgkmcnt(6)
  v_mfma_f32_16x16x32_bf16 v[204:207], v[224:227], v[24:27], v[204:207]
  v_mfma_f32_16x16x32_bf16 v[208:211], v[224:227], v[28:31], v[208:211]
  v_mfma_f32_16x16x32_bf16 v[212:215], v[224:227], v[32:35], v[212:215]
  ds_read_b64_tr_b16 v[224:225], v245 offset:18432
  ds_read_b64_tr_b16 v[226:227], v245 offset:18944
  s_waitcnt lgkmcnt(6)
  v_mfma_f32_16x16x32_bf16 v[204:207], v[228:231], v[36:39], v[204:207]
  v_mfma_f32_16x16x32_bf16 v[208:211], v[228:231], v[40:43], v[208:211]
  v_mfma_f32_16x16x32_bf16 v[212:215], v[228:231], v[44:47], v[212:215]
  ds_read_b64_tr_b16 v[228:229], v245 offset:19456
  ds_read_b64_tr_b16 v[230:231], v245 offset:19968
  s_waitcnt lgkmcnt(6)
  v_mfma_f32_16x16x32_bf16 v[204:207], v[216:219], v[48:51], v[204:207]
  v_mfma_f32_16x16x32_bf16 v[208:211], v[216:219], v[52:55], v[208:211]
  v_mfma_f32_16x16x32_bf16 v[212:215], v[216:219], v[56:59], v[212:215]
  s_waitcnt vmcnt(10)
  s_barrier
  ds_read_b64_tr_b16 v[216:217], v245 offset:32768
  ds_read_b64_tr_b16 v[218:219], v245 offset:33280
  s_waitcnt lgkmcnt(6)
  v_mfma_f32_16x16x32_bf16 v[204:207], v[220:223], v[60:63], v[204:207]
  s_lshl_b32 s73, s17, 7
  s_add_u32 m0, s69, 32768
  s_add_u32 s64, s73, 0
  buffer_load_dwordx4 v243, s[40:43], s64 offen lds
  v_mfma_f32_16x16x32_bf16 v[208:211], v[220:223], v[64:67], v[208:211]
  v_mfma_f32_16x16x32_bf16 v[212:215], v[220:223], v[68:71], v[212:215]
  ds_read_b64_tr_b16 v[220:221], v245 offset:33792
  ds_read_b64_tr_b16 v[222:223], v245 offset:34304
  s_waitcnt lgkmcnt(6)
  v_mfma_f32_16x16x32_bf16 v[204:207], v[224:227], v[72:75], v[204:207]
  s_add_u32 m0, s69, 33792
  s_add_u32 s64, s73, 8192
  buffer_load_dwordx4 v243, s[40:43], s64 offen lds
  v_mfma_f32_16x16x32_bf16 v[208:211], v[224:227], v[76:79], v[208:211]
  v_mfma_f32_16x16x32_bf16 v[212:215], v[224:227], v[80:83], v[212:215]
  ds_read_b64_tr_b16 v[224:225], v245 offset:34816
  ds_read_b64_tr_b16 v[226:227], v245 offset:35328
  s_waitcnt lgkmcnt(6)
  v_mfma_f32_16x16x32_bf16 v[204:207], v[228:231], v[84:87], v[204:207]
  s_add_u32 m0, s69, 34816
  s_add_u32 s64, s73, 16384
  buffer_load_dwordx4 v243, s[40:43], s64 offen lds
  v_mfma_f32_16x16x32_bf16 v[208:211], v[228:231], v[88:91], v[208:211]
  v_mfma_f32_16x16x32_bf16 v[212:215], v[228:231], v[92:95], v[212:215]
  ds_read_b64_tr_b16 v[228:229], v245 offset:35840
  ds_read_b64_tr_b16 v[230:231], v245 offset:36352
  s_waitcnt lgkmcnt(6)
  v_mfma_f32_16x16x32_bf16 v[204:207], v[216:219], v[96:99], v[204:207]
  s_add_u32 m0, s69, 35840
  s_add_u32 s64, s73, 24576
  buffer_load_dwordx4 v243, s[40:43], s64 offen lds
  v_mfma_f32_16x16x32_bf16 v[208:211], v[216:219], v[100:103], v[208:211]
  v_mfma_f32_16x16x32_bf16 v[212:215], v[216:219], v[104:107], v[212:215]
  ds_read_b64_tr_b16 v[216:217], v245 offset:49152
  ds_read_b64_tr_b16 v[218:219], v245 offset:49664
  s_waitcnt lgkmcnt(6)
  v_mfma_f32_16x16x32_bf16 v[204:207], v[220:223], v[108:111], v[204:207]
  v_mfma_f32_16x16x32_bf16 v[208:211], v[220:223], v[112:115], v[208:211]
  v_mfma_f32_16x16x32_bf16 v[212:215], v[220:223], v[116:119], v[212:215]
  ds_read_b64_tr_b16 v[220:221], v245 offset:50176
  ds_read_b64_tr_b16 v[222:223], v245 offset:50688
  s_waitcnt lgkmcnt(6)
  v_mfma_f32_16x16x32_bf16 v[204:207], v[224:227], v[120:123], v[204:207]
  v_mfma_f32_16x16x32_bf16 v[208:211], v[224:227], v[124:127], v[208:211]
  v_mfma_f32_16x16x32_bf16 v[212:215], v[224:227], v[128:131], v[212:215]
  ds_read_b64_tr_b16 v[224:225], v245 offset:51200
  ds_read_b64_tr_b16 v[226:227], v245 offset:51712
  s_waitcnt lgkmcnt(6)
  v_mfma_f32_16x16x32_bf16 v[204:207], v[228:231], v[132:135], v[204:207]
  v_mfma_f32_16x16x32_bf16 v[208:211], v[228:231], v[136:139], v[208:211]
  v_mfma_f32_16x16x32_bf16 v[212:215], v[228:231], v[140:143], v[212:215]
  ds_read_b64_tr_b16 v[228:229], v245 offset:52224
  ds_read_b64_tr_b16 v[230:231], v245 offset:52736
  s_waitcnt lgkmcnt(6)
  v_mfma_f32_16x16x32_bf16 v[204:207], v[216:219], v[144:147], v[204:207]
  v_mfma_f32_16x16x32_bf16 v[208:211], v[216:219], v[148:151], v[208:211]
  v_mfma_f32_16x16x32_bf16 v[212:215], v[216:219], v[152:155], v[212:215]
  s_waitcnt vmcnt(10)
  s_barrier
  ds_read_b64_tr_b16 v[216:217], v246 offset:0
  ds_read_b64_tr_b16 v[218:219], v246 offset:512
  s_waitcnt lgkmcnt(6)
  v_mfma_f32_16x16x32_bf16 v[204:207], v[220:223], v[156:159], v[204:207]
  s_lshl_b32 s73, s17, 7
  s_add_u32 m0, s69, 65536
  s_add_u32 s64, s73, 262144
  buffer_load_dwordx4 v243, s[40:43], s64 offen lds
  v_mfma_f32_16x16x32_bf16 v[208:211], v[220:223], v[160:163], v[208:211]
  v_mfma_f32_16x16x32_bf16 v[212:215], v[220:223], v[164:167], v[212:215]
  ds_read_b64_tr_b16 v[220:221], v246 offset:1024
  ds_read_b64_tr_b16 v[222:223], v246 offset:1536
  s_waitcnt lgkmcnt(6)
  v_mfma_f32_16x16x32_bf16 v[204:207], v[224:227], v[168:171], v[204:207]
  s_add_u32 m0, s69, 66560
  s_add_u32 s64, s73, 270336
  buffer_load_dwordx4 v243, s[40:43], s64 offen lds
  v_mfma_f32_16x16x32_bf16 v[208:211], v[224:227], v[172:175], v[208:211]
  v_mfma_f32_16x16x32_bf16 v[212:215], v[224:227], v[176:179], v[212:215]
  ds_read_b64_tr_b16 v[224:225], v246 offset:2048
  ds_read_b64_tr_b16 v[226:227], v246 offset:2560
  s_waitcnt lgkmcnt(6)
  v_mfma_f32_16x16x32_bf16 v[204:207], v[228:231], v[180:183], v[204:207]
  s_add_u32 m0, s69, 67584
  s_add_u32 s64, s73, 278528
  buffer_load_dwordx4 v243, s[40:43], s64 offen lds
  v_mfma_f32_16x16x32_bf16 v[208:211], v[228:231], v[184:187], v[208:211]
  v_mfma_f32_16x16x32_bf16 v[212:215], v[228:231], v[188:191], v[212:215]
  ds_read_b64_tr_b16 v[228:229], v246 offset:3072
  ds_read_b64_tr_b16 v[230:231], v246 offset:3584
  s_waitcnt lgkmcnt(6)
  v_mfma_f32_16x16x32_bf16 v[192:195], v[216:219], v[0:3], 0
  s_add_u32 m0, s69, 68608
  s_add_u32 s64, s73, 286720
  buffer_load_dwordx4 v243, s[40:43], s64 offen lds
  v_mfma_f32_16x16x32_bf16 v[196:199], v[216:219], v[4:7], 0
  v_mfma_f32_16x16x32_bf16 v[200:203], v[216:219], v[8:11], 0
  ds_read_b64_tr_b16 v[216:217], v246 offset:16384
  ds_read_b64_tr_b16 v[218:219], v246 offset:16896
  s_waitcnt lgkmcnt(6)
  v_mfma_f32_16x16x32_bf16 v[192:195], v[220:223], v[12:15], v[192:195]
  s_waitcnt vmcnt(8)
  s_mov_b32 s65, 131072
Lrdy:
  v_and_b32 v250, v250, v251
  s_nop 0
  v_readfirstlane_b32 s64, v250
  s_nop 3
  s_and_b32 s64, s64, 16843009
  s_cmp_eq_u32 s64, 16843009
  s_cbranch_scc1 Lrdy_ok
  s_sub_u32 s65, s65, 1
  s_cbranch_scc1 Lrdy_ok
  buffer_load_dwordx2 v[250:251], v254, s[52:55], 0 offen sc1
  s_waitcnt vmcnt(0)
  s_branch Lrdy
Lrdy_ok:
  v_mov_b32 v249, 1
  s_lshl_b32 s65, s14, 7
  s_add_u32 s65, s65, s23
  s_mov_b64 exec, 1
  buffer_atomic_add v249, off, s[48:51], s65 sc1
  s_mov_b64 exec, -1
  v_mfma_f32_16x16x32_bf16 v[196:199], v[220:223], v[16:19], v[196:199]
  v_mfma_f32_16x16x32_bf16 v[200:203], v[220:223], v[20:23], v[200:203]
  ds_read_b64_tr_b16 v[220:221], v246 offset:17408
  ds_read_b64_tr_b16 v[222:223], v246 offset:17920
  s_waitcnt lgkmcnt(6)
  v_mfma_f32_16x16x32_bf16 v[192:195], v[224:227], v[24:27], v[192:195]
  v_cvt_pk_bf16_f32 v234, v204, v205
  v_cvt_pk_bf16_f32 v235, v206, v207
  v_cvt_pk_bf16_f32 v236, v208, v209
  v_cvt_pk_bf16_f32 v237, v210, v211
  v_cvt_pk_bf16_f32 v238, v212, v213
  v_cvt_pk_bf16_f32 v239, v214, v215
  s_mul_i32 s65, s15, 98304
  s_add_u32 s65, s65, s22
  buffer_store_dwordx4 v[234:237], v247, s[48:51], s65 offen sc1
  buffer_store_dwordx2 v[238:239], v253, s[48:51], s65 offen offset:1024 sc1
  v_mfma_f32_16x16x32_bf16 v[196:199], v[224:227], v[28:31], v[196:199]
  v_mfma_f32_16x16x32_bf16 v[200:203], v[224:227], v[32:35], v[200:203]
  ds_read_b64_tr_b16 v[224:225], v246 offset:18432
  ds_read_b64_tr_b16 v[226:227], v246 offset:18944
  s_waitcnt lgkmcnt(6)
  v_mfma_f32_16x16x32_bf16 v[192:195], v[228:231], v[36:39], v[192:195]
  v_mfma_f32_16x16x32_bf16 v[196:199], v[228:231], v[40:43], v[196:199]
  v_mfma_f32_16x16x32_bf16 v[200:203], v[228:231], v[44:47], v[200:203]
  ds_read_b64_tr_b16 v[228:229], v246 offset:19456
  ds_read_b64_tr_b16 v[230:231], v246 offset:19968
  s_waitcnt lgkmcnt(6)
  v_mfma_f32_16x16x32_bf16 v[192:195], v[216:219], v[48:51], v[192:195]
  v_mfma_f32_16x16x32_bf16 v[196:199], v[216:219], v[52:55], v[196:199]
  v_mfma_f32_16x16x32_bf16 v[200:203], v[216:219], v[56:59], v[200:203]
  s_barrier
  ds_read_b64_tr_b16 v[216:217], v244 offset:0
  ds_read_b64_tr_b16 v[218:219], v244 offset:512
  s_waitcnt lgkmcnt(6)
  v_mfma_f32_16x16x32_bf16 v[192:195], v[220:223], v[60:63], v[192:195]
  s_lshl_b32 s73, s18, 7
  s_add_u32 m0, s69, 98304
  s_add_u32 s64, s73, 0
  buffer_load_dwordx4 v243, s[40:43], s64 offen lds
  v_mfma_f32_16x16x32_bf16 v[196:199], v[220:223], v[64:67], v[196:199]
  v_mfma_f32_16x16x32_bf16 v[200:203], v[220:223], v[68:71], v[200:203]
  ds_read_b64_tr_b16 v[220:221], v244 offset:1024
  ds_read_b64_tr_b16 v[222:223], v244 offset:1536
  s_waitcnt lgkmcnt(6)
  v_mfma_f32_16x16x32_bf16 v[192:195], v[224:227], v[72:75], v[192:195]
  s_add_u32 m0, s69, 99328
  s_add_u32 s64, s73, 8192
  buffer_load_dwordx4 v243, s[40:43], s64 offen lds
  v_mfma_f32_16x16x32_bf16 v[196:199], v[224:227], v[76:79], v[196:199]
  v_mfma_f32_16x16x32_bf16 v[200:203], v[224:227], v[80:83], v[200:203]
  ds_read_b64_tr_b16 v[224:225], v244 offset:2048
  ds_read_b64_tr_b16 v[226:227], v244 offset:2560
  s_waitcnt lgkmcnt(6)
  v_mfma_f32_16x16x32_bf16 v[192:195], v[228:231], v[84:87], v[192:195]
  s_add_u32 m0, s69, 100352
  s_add_u32 s64, s73, 16384
  buffer_load_dwordx4 v243, s[40:43], s64 offen lds
  v_mfma_f32_16x16x32_bf16 v[196:199], v[228:231], v[88:91], v[196:199]
  v_mfma_f32_16x16x32_bf16 v[200:203], v[228:231], v[92:95], v[200:203]
  ds_read_b64_tr_b16 v[228:229], v244 offset:3072
  ds_read_b64_tr_b16 v[230:231], v244 offset:3584
  s_waitcnt lgkmcnt(6)
  v_mfma_f32_16x16x32_bf16 v[192:195], v[216:219], v[96:99], v[192:195]
  s_add_u32 m0, s69, 101376
  s_add_u32 s64, s73, 24576
  buffer_load_dwordx4 v243, s[40:43], s64 offen lds
  v_mfma_f32_16x16x32_bf16 v[196:199], v[216:219], v[100:103], v[196:199]
  v_mfma_f32_16x16x32_bf16 v[200:203], v[216:219], v[104:107], v[200:203]
  ds_read_b64_tr_b16 v[216:217], v244 offset:16384
  ds_read_b64_tr_b16 v[218:219], v244 offset:16896
  s_waitcnt lgkmcnt(6)
  v_mfma_f32_16x16x32_bf16 v[192:195], v[220:223], v[108:111], v[192:195]
  v_mfma_f32_16x16x32_bf16 v[196:199], v[220:223], v[112:115], v[196:199]
  v_mfma_f32_16x16x32_bf16 v[200:203], v[220:223], v[116:119], v[200:203]
  ds_read_b64_tr_b16 v[220:221], v244 offset:17408
  ds_read_b64_tr_b16 v[222:223], v244 offset:17920
  s_waitcnt lgkmcnt(6)
  v_mfma_f32_16x16x32_bf16 v[192:195], v[224:227], v[120:123], v[192:195]
  v_mfma_f32_16x16x32_bf16 v[196:199], v[224:227], v[124:127], v[196:199]
  v_mfma_f32_16x16x32_bf16 v[200:203], v[224:227], v[128:131], v[200:203]
  ds_read_b64_tr_b16 v[224:225], v244 offset:18432
  ds_read_b64_tr_b16 v[226:227], v244 offset:18944
  s_waitcnt lgkmcnt(6)
  v_mfma_f32_16x16x32_bf16 v[192:195], v[228:231], v[132:135], v[192:195]
  v_mfma_f32_16x16x32_bf16 v[196:199], v[228:231], v[136:139], v[196:199]
  v_mfma_f32_16x16x32_bf16 v[200:203], v[228:231], v[140:143], v[200:203]
  ds_read_b64_tr_b16 v[228:229], v244 offset:19456
  ds_read_b64_tr_b16 v[230:231], v244 offset:19968
  s_waitcnt lgkmcnt(6)
  v_mfma_f32_16x16x32_bf16 v[192:195], v[216:219], v[144:147], v[192:195]
  v_mfma_f32_16x16x32_bf16 v[196:199], v[216:219], v[148:151], v[196:199]
  v_mfma_f32_16x16x32_bf16 v[200:203], v[216:219], v[152:155], v[200:203]
  s_waitcnt vmcnt(11)
  s_barrier
  ds_read_b64_tr_b16 v[216:217], v244 offset:32768
  ds_read_b64_tr_b16 v[218:219], v244 offset:33280
  s_waitcnt lgkmcnt(6)
  v_mfma_f32_16x16x32_bf16 v[192:195], v[220:223], v[156:159], v[192:195]
  s_lshl_b32 s73, s18, 7
  s_add_u32 m0, s69, 131072
  s_add_u32 s64, s73, 262144
  buffer_load_dwordx4 v243, s[40:43], s64 offen lds
  v_mfma_f32_16x16x32_bf16 v[196:199], v[220:223], v[160:163], v[196:199]
  v_mfma_f32_16x16x32_bf16 v[200:203], v[220:223], v[164:167], v[200:203]
  ds_read_b64_tr_b16 v[220:221], v244 offset:33792
  ds_read_b64_tr_b16 v[222:223], v244 offset:34304
  s_waitcnt lgkmcnt(6)
  v_mfma_f32_16x16x32_bf16 v[192:195], v[224:227], v[168:171], v[192:195]
  s_add_u32 m0, s69, 132096
  s_add_u32 s64, s73, 270336
  buffer_load_dwordx4 v243, s[40:43], s64 offen lds
  v_mfma_f32_16x16x32_bf16 v[196:199], v[224:227], v[172:175], v[196:199]
  v_mfma_f32_16x16x32_bf16 v[200:203], v[224:227], v[176:179], v[200:203]
  ds_read_b64_tr_b16 v[224:225], v244 offset:34816
  ds_read_b64_tr_b16 v[226:227], v244 offset:35328
  s_waitcnt lgkmcnt(6)
  v_mfma_f32_16x16x32_bf16 v[192:195], v[228:231], v[180:183], v[192:195]
  s_add_u32 m0, s69, 133120
  s_add_u32 s64, s73, 278528
  buffer_load_dwordx4 v243, s[40:43], s64 offen lds
  v_mfma_f32_16x16x32_bf16 v[196:199], v[228:231], v[184:187], v[196:199]
  v_mfma_f32_16x16x32_bf16 v[200:203], v[228:231], v[188:191], v[200:203]
  ds_read_b64_tr_b16 v[228:229], v244 offset:35840
  ds_read_b64_tr_b16 v[230:231], v244 offset:36352
  s_waitcnt lgkmcnt(6)
  v_mfma_f32_16x16x32_bf16 v[204:207], v[216:219], v[0:3], 0
  s_add_u32 m0, s69, 134144
  s_add_u32 s64, s73, 286720
  buffer_load_dwordx4 v243, s[40:43], s64 offen lds
  v_mfma_f32_16x16x32_bf16 v[208:211], v[216:219], v[4:7], 0
  v_mfma_f32_16x16x32_bf16 v[212:215], v[216:219], v[8:11], 0
  ds_read_b64_tr_b16 v[216:217], v244 offset:49152
  ds_read_b64_tr_b16 v[218:219], v244 offset:49664
  s_waitcnt lgkmcnt(6)
  v_mfma_f32_16x16x32_bf16 v[204:207], v[220:223], v[12:15], v[204:207]
  s_waitcnt vmcnt(8)
  v_mov_b32 v249, 2
  s_lshl_b32 s65, s15, 7
  s_add_u32 s65, s65, s23
  s_mov_b64 exec, 1
  buffer_atomic_add v249, off, s[48:51], s65 sc1
  s_mov_b64 exec, -1
  v_mfma_f32_16x16x32_bf16 v[208:211], v[220:223], v[16:19], v[208:211]
  v_mfma_f32_16x16x32_bf16 v[212:215], v[220:223], v[20:23], v[212:215]
  ds_read_b64_tr_b16 v[220:221], v244 offset:50176
  ds_read_b64_tr_b16 v[222:223], v244 offset:50688
  s_waitcnt lgkmcnt(6)
  v_mfma_f32_16x16x32_bf16 v[204:207], v[224:227], v[24:27], v[204:207]
  v_cvt_pk_bf16_f32 v234, v192, v193
  v_cvt_pk_bf16_f32 v235, v194, v195
  v_cvt_pk_bf16_f32 v236, v196, v197
  v_cvt_pk_bf16_f32 v237, v198, v199
  v_cvt_pk_bf16_f32 v238, v200, v201
  v_cvt_pk_bf16_f32 v239, v202, v203
  s_mul_i32 s65, s16, 98304
  s_add_u32 s65, s65, s22
  buffer_store_dwordx4 v[234:237], v247, s[48:51], s65 offen sc1
  buffer_store_dwordx2 v[238:239], v253, s[48:51], s65 offen offset:1024 sc1
  v_mfma_f32_16x16x32_bf16 v[208:211], v[224:227], v[28:31], v[208:211]
  v_mfma_f32_16x16x32_bf16 v[212:215], v[224:227], v[32:35], v[212:215]
  ds_read_b64_tr_b16 v[224:225], v244 offset:51200
  ds_read_b64_tr_b16 v[226:227], v244 offset:51712
  s_waitcnt lgkmcnt(6)
  v_mfma_f32_16x16x32_bf16 v[204:207], v[228:231], v[36:39], v[204:207]
  v_mfma_f32_16x16x32_bf16 v[208:211], v[228:231], v[40:43], v[208:211]
  v_mfma_f32_16x16x32_bf16 v[212:215], v[228:231], v[44:47], v[212:215]
  ds_read_b64_tr_b16 v[228:229], v244 offset:52224
  ds_read_b64_tr_b16 v[230:231], v244 offset:52736
  s_waitcnt lgkmcnt(6)
  v_mfma_f32_16x16x32_bf16 v[204:207], v[216:219], v[48:51], v[204:207]
  v_mfma_f32_16x16x32_bf16 v[208:211], v[216:219], v[52:55], v[208:211]
  v_mfma_f32_16x16x32_bf16 v[212:215], v[216:219], v[56:59], v[212:215]
  s_barrier
  ds_read_b64_tr_b16 v[216:217], v245 offset:0
  ds_read_b64_tr_b16 v[218:219], v245 offset:512
  s_waitcnt lgkmcnt(6)
  v_mfma_f32_16x16x32_bf16 v[204:207], v[220:223], v[60:63], v[204:207]
  s_lshl_b32 s73, s19, 7
  s_add_u32 m0, s69, 0
  s_add_u32 s64, s73, 0
  buffer_load_dwordx4 v243, s[40:43], s64 offen lds
  v_mfma_f32_16x16x32_bf16 v[208:211], v[220:223], v[64:67], v[208:211]
  v_mfma_f32_16x16x32_bf16 v[212:215], v[220:223], v[68:71], v[212:215]
  ds_read_b64_tr_b16 v[220:221], v245 offset:1024
  ds_read_b64_tr_b16 v[222:223], v245 offset:1536
  s_waitcnt lgkmcnt(6)
  v_mfma_f32_16x16x32_bf16 v[204:207], v[224:227], v[72:75], v[204:207]
  s_add_u32 m0, s69, 1024
  s_add_u32 s64, s73, 8192
  buffer_load_dwordx4 v243, s[40:43], s64 offen lds
  v_mfma_f32_16x16x32_bf16 v[208:211], v[224:227], v[76:79], v[208:211]
  v_mfma_f32_16x16x32_bf16 v[212:215], v[224:227], v[80:83], v[212:215]
  ds_read_b64_tr_b16 v[224:225], v245 offset:2048
  ds_read_b64_tr_b16 v[226:227], v245 offset:2560
  s_waitcnt lgkmcnt(6)
  v_mfma_f32_16x16x32_bf16 v[204:207], v[228:231], v[84:87], v[204:207]
  s_add_u32 m0, s69, 2048
  s_add_u32 s64, s73, 16384
  buffer_load_dwordx4 v243, s[40:43], s64 offen lds
  v_mfma_f32_16x16x32_bf16 v[208:211], v[228:231], v[88:91], v[208:211]
  v_mfma_f32_16x16x32_bf16 v[212:215], v[228:231], v[92:95], v[212:215]
  ds_read_b64_tr_b16 v[228:229], v245 offset:3072
  ds_read_b64_tr_b16 v[230:231], v245 offset:3584
  s_waitcnt lgkmcnt(6)
  v_mfma_f32_16x16x32_bf16 v[204:207], v[216:219], v[96:99], v[204:207]
  s_add_u32 m0, s69, 3072
  s_add_u32 s64, s73, 24576
  buffer_load_dwordx4 v243, s[40:43], s64 offen lds
  v_mfma_f32_16x16x32_bf16 v[208:211], v[216:219], v[100:103], v[208:211]
  v_mfma_f32_16x16x32_bf16 v[212:215], v[216:219], v[104:107], v[212:215]
  ds_read_b64_tr_b16 v[216:217], v245 offset:16384
  ds_read_b64_tr_b16 v[218:219], v245 offset:16896
  s_waitcnt lgkmcnt(6)
  v_mfma_f32_16x16x32_bf16 v[204:207], v[220:223], v[108:111], v[204:207]
  v_mfma_f32_16x16x32_bf16 v[208:211], v[220:223], v[112:115], v[208:211]
  v_mfma_f32_16x16x32_bf16 v[212:215], v[220:223], v[116:119], v[212:215]
  ds_read_b64_tr_b16 v[220:221], v245 offset:17408
  ds_read_b64_tr_b16 v[222:223], v245 offset:17920
  s_waitcnt lgkmcnt(6)
  v_mfma_f32_16x16x32_bf16 v[204:207], v[224:227], v[120:123], v[204:207]
  v_mfma_f32_16x16x32_bf16 v[208:211], v[224:227], v[124:127], v[208:211]
  v_mfma_f32_16x16x32_bf16 v[212:215], v[224:227], v[128:131], v[212:215]
  ds_read_b64_tr_b16 v[224:225], v245 offset:18432
  ds_read_b64_tr_b16 v[226:227], v245 offset:18944
  s_waitcnt lgkmcnt(6)
  v_mfma_f32_16x16x32_bf16 v[204:207], v[228:231], v[132:135], v[204:207]
  v_mfma_f32_16x16x32_bf16 v[208:211], v[228:231], v[136:139], v[208:211]
  v_mfma_f32_16x16x32_bf16 v[212:215], v[228:231], v[140:143], v[212:215]
  ds_read_b64_tr_b16 v[228:229], v245 offset:19456
  ds_read_b64_tr_b16 v[230:231], v245 offset:19968
  s_waitcnt lgkmcnt(6)
  v_mfma_f32_16x16x32_bf16 v[204:207], v[216:219], v[144:147], v[204:207]
  v_mfma_f32_16x16x32_bf16 v[208:211], v[216:219], v[148:151], v[208:211]
  v_mfma_f32_16x16x32_bf16 v[212:215], v[216:219], v[152:155], v[212:215]
  s_waitcnt vmcnt(11)
  s_barrier
  ds_read_b64_tr_b16 v[216:217], v245 offset:32768
  ds_read_b64_tr_b16 v[218:219], v245 offset:33280
  s_waitcnt lgkmcnt(6)
  v_mfma_f32_16x16x32_bf16 v[204:207], v[220:223], v[156:159], v[204:207]
  s_lshl_b32 s73, s19, 7
  s_add_u32 m0, s69, 32768
  s_add_u32 s64, s73, 262144
  buffer_load_dwordx4 v243, s[40:43], s64 offen lds
  v_mfma_f32_16x16x32_bf16 v[208:211], v[220:223], v[160:163], v[208:211]
  v_mfma_f32_16x16x32_bf16 v[212:215], v[220:223], v[164:167], v[212:215]
  ds_read_b64_tr_b16 v[220:221], v245 offset:33792
  ds_read_b64_tr_b16 v[222:223], v245 offset:34304
  s_waitcnt lgkmcnt(6)
  v_mfma_f32_16x16x32_bf16 v[204:207], v[224:227], v[168:171], v[204:207]
  s_add_u32 m0, s69, 33792
  s_add_u32 s64, s73, 270336
  buffer_load_dwordx4 v243, s[40:43], s64 offen lds
  v_mfma_f32_16x16x32_bf16 v[208:211], v[224:227], v[172:175], v[208:211]
  v_mfma_f32_16x16x32_bf16 v[212:215], v[224:227], v[176:179], v[212:215]
  ds_read_b64_tr_b16 v[224:225], v245 offset:34816
  ds_read_b64_tr_b16 v[226:227], v245 offset:35328
  s_waitcnt lgkmcnt(6)
  v_mfma_f32_16x16x32_bf16 v[204:207], v[228:231], v[180:183], v[204:207]
  s_add_u32 m0, s69, 34816
  s_add_u32 s64, s73, 278528
  buffer_load_dwordx4 v243, s[40:43], s64 offen lds
  v_mfma_f32_16x16x32_bf16 v[208:211], v[228:231], v[184:187], v[208:211]
  v_mfma_f32_16x16x32_bf16 v[212:215], v[228:231], v[188:191], v[212:215]
  ds_read_b64_tr_b16 v[228:229], v245 offset:35840
  ds_read_b64_tr_b16 v[230:231], v245 offset:36352
  s_waitcnt lgkmcnt(6)
  v_mfma_f32_16x16x32_bf16 v[192:195], v[216:219], v[0:3], 0
  s_add_u32 m0, s69, 35840
  s_add_u32 s64, s73, 286720
  buffer_load_dwordx4 v243, s[40:43], s64 offen lds
  v_mfma_f32_16x16x32_bf16 v[196:199], v[216:219], v[4:7], 0
  v_mfma_f32_16x16x32_bf16 v[200:203], v[216:219], v[8:11], 0
  ds_read_b64_tr_b16 v[216:217], v245 offset:49152
  ds_read_b64_tr_b16 v[218:219], v245 offset:49664
  s_waitcnt lgkmcnt(6)
  v_mfma_f32_16x16x32_bf16 v[192:195], v[220:223], v[12:15], v[192:195]
  s_waitcnt vmcnt(8)
  v_mov_b32 v249, 4
  s_lshl_b32 s65, s16, 7
  s_add_u32 s65, s65, s23
  s_mov_b64 exec, 1
  buffer_atomic_add v249, off, s[48:51], s65 sc1
  s_mov_b64 exec, -1
  v_mfma_f32_16x16x32_bf16 v[196:199], v[220:223], v[16:19], v[196:199]
  v_mfma_f32_16x16x32_bf16 v[200:203], v[220:223], v[20:23], v[200:203]
  ds_read_b64_tr_b16 v[220:221], v245 offset:50176
  ds_read_b64_tr_b16 v[222:223], v245 offset:50688
  s_waitcnt lgkmcnt(6)
  v_mfma_f32_16x16x32_bf16 v[192:195], v[224:227], v[24:27], v[192:195]
  v_cvt_pk_bf16_f32 v234, v204, v205
  v_cvt_pk_bf16_f32 v235, v206, v207
  v_cvt_pk_bf16_f32 v236, v208, v209
  v_cvt_pk_bf16_f32 v237, v210, v211
  v_cvt_pk_bf16_f32 v238, v212, v213
  v_cvt_pk_bf16_f32 v239, v214, v215
  s_mul_i32 s65, s17, 98304
  s_add_u32 s65, s65, s22
  buffer_store_dwordx4 v[234:237], v247, s[48:51], s65 offen sc1
  buffer_store_dwordx2 v[238:239], v253, s[48:51], s65 offen offset:1024 sc1
  v_mfma_f32_16x16x32_bf16 v[196:199], v[224:227], v[28:31], v[196:199]
  v_mfma_f32_16x16x32_bf16 v[200:203], v[224:227], v[32:35], v[200:203]
  ds_read_b64_tr_b16 v[224:225], v245 offset:51200
  ds_read_b64_tr_b16 v[226:227], v245 offset:51712
  s_waitcnt lgkmcnt(6)
  v_mfma_f32_16x16x32_bf16 v[192:195], v[228:231], v[36:39], v[192:195]
  v_mfma_f32_16x16x32_bf16 v[196:199], v[228:231], v[40:43], v[196:199]
  v_mfma_f32_16x16x32_bf16 v[200:203], v[228:231], v[44:47], v[200:203]
  ds_read_b64_tr_b16 v[228:229], v245 offset:52224
  ds_read_b64_tr_b16 v[230:231], v245 offset:52736
  s_waitcnt lgkmcnt(6)
  v_mfma_f32_16x16x32_bf16 v[192:195], v[216:219], v[48:51], v[192:195]
  v_mfma_f32_16x16x32_bf16 v[196:199], v[216:219], v[52:55], v[196:199]
  v_mfma_f32_16x16x32_bf16 v[200:203], v[216:219], v[56:59], v[200:203]
  s_barrier
  ds_read_b64_tr_b16 v[216:217], v246 offset:0
  ds_read_b64_tr_b16 v[218:219], v246 offset:512
  s_waitcnt lgkmcnt(6)
  v_mfma_f32_16x16x32_bf16 v[192:195], v[220:223], v[60:63], v[192:195]
  s_lshl_b32 s73, s20, 7
  s_add_u32 m0, s69, 65536
  s_add_u32 s64, s73, 0
  buffer_load_dwordx4 v243, s[40:43], s64 offen lds
  v_mfma_f32_16x16x32_bf16 v[196:199], v[220:223], v[64:67], v[196:199]
  v_mfma_f32_16x16x32_bf16 v[200:203], v[220:223], v[68:71], v[200:203]
  ds_read_b64_tr_b16 v[220:221], v246 offset:1024
  ds_read_b64_tr_b16 v[222:223], v246 offset:1536
  s_waitcnt lgkmcnt(6)
  v_mfma_f32_16x16x32_bf16 v[192:195], v[224:227], v[72:75], v[192:195]
  s_add_u32 m0, s69, 66560
  s_add_u32 s64, s73, 8192
  buffer_load_dwordx4 v243, s[40:43], s64 offen lds
  v_mfma_f32_16x16x32_bf16 v[196:199], v[224:227], v[76:79], v[196:199]
  v_mfma_f32_16x16x32_bf16 v[200:203], v[224:227], v[80:83], v[200:203]
  ds_read_b64_tr_b16 v[224:225], v246 offset:2048
  ds_read_b64_tr_b16 v[226:227], v246 offset:2560
  s_waitcnt lgkmcnt(6)
  v_mfma_f32_16x16x32_bf16 v[192:195], v[228:231], v[84:87], v[192:195]
  s_add_u32 m0, s69, 67584
  s_add_u32 s64, s73, 16384
  buffer_load_dwordx4 v243, s[40:43], s64 offen lds
  v_mfma_f32_16x16x32_bf16 v[196:199], v[228:231], v[88:91], v[196:199]
  v_mfma_f32_16x16x32_bf16 v[200:203], v[228:231], v[92:95], v[200:203]
  ds_read_b64_tr_b16 v[228:229], v246 offset:3072
  ds_read_b64_tr_b16 v[230:231], v246 offset:3584
  s_waitcnt lgkmcnt(6)
  v_mfma_f32_16x16x32_bf16 v[192:195], v[216:219], v[96:99], v[192:195]
  s_add_u32 m0, s69, 68608
  s_add_u32 s64, s73, 24576
  buffer_load_dwordx4 v243, s[40:43], s64 offen lds
  v_mfma_f32_16x16x32_bf16 v[196:199], v[216:219], v[100:103], v[196:199]
  v_mfma_f32_16x16x32_bf16 v[200:203], v[216:219], v[104:107], v[200:203]
  ds_read_b64_tr_b16 v[216:217], v246 offset:16384
  ds_read_b64_tr_b16 v[218:219], v246 offset:16896
  s_waitcnt lgkmcnt(6)
  v_mfma_f32_16x16x32_bf16 v[192:195], v[220:223], v[108:111], v[192:195]
  v_mfma_f32_16x16x32_bf16 v[196:199], v[220:223], v[112:115], v[196:199]
  v_mfma_f32_16x16x32_bf16 v[200:203], v[220:223], v[116:119], v[200:203]
  ds_read_b64_tr_b16 v[220:221], v246 offset:17408
  ds_read_b64_tr_b16 v[222:223], v246 offset:17920
  s_waitcnt lgkmcnt(6)
  v_mfma_f32_16x16x32_bf16 v[192:195], v[224:227], v[120:123], v[192:195]
  v_mfma_f32_16x16x32_bf16 v[196:199], v[224:227], v[124:127], v[196:199]
  v_mfma_f32_16x16x32_bf16 v[200:203], v[224:227], v[128:131], v[200:203]
  ds_read_b64_tr_b16 v[224:225], v246 offset:18432
  ds_read_b64_tr_b16 v[226:227], v246 offset:18944
  s_waitcnt lgkmcnt(6)
  v_mfma_f32_16x16x32_bf16 v[192:195], v[228:231], v[132:135], v[192:195]
  v_mfma_f32_16x16x32_bf16 v[196:199], v[228:231], v[136:139], v[196:199]
  v_mfma_f32_16x16x32_bf16 v[200:203], v[228:231], v[140:143], v[200:203]
  ds_read_b64_tr_b16 v[228:229], v246 offset:19456
  ds_read_b64_tr_b16 v[230:231], v246 offset:19968
  s_waitcnt lgkmcnt(6)
  v_mfma_f32_16x16x32_bf16 v[192:195], v[216:219], v[144:147], v[192:195]
  v_mfma_f32_16x16x32_bf16 v[196:199], v[216:219], v[148:151], v[196:199]
  v_mfma_f32_16x16x32_bf16 v[200:203], v[216:219], v[152:155], v[200:203]
  s_waitcnt vmcnt(11)
  s_barrier
  ds_read_b64_tr_b16 v[216:217], v244 offset:0
  ds_read_b64_tr_b16 v[218:219], v244 offset:512
  s_waitcnt lgkmcnt(6)
  v_mfma_f32_16x16x32_bf16 v[192:195], v[220:223], v[156:159], v[192:195]
  s_lshl_b32 s73, s20, 7
  s_add_u32 m0, s69, 98304
  s_add_u32 s64, s73, 262144
  buffer_load_dwordx4 v243, s[40:43], s64 offen lds
  v_mfma_f32_16x16x32_bf16 v[196:199], v[220:223], v[160:163], v[196:199]
  v_mfma_f32_16x16x32_bf16 v[200:203], v[220:223], v[164:167], v[200:203]
  ds_read_b64_tr_b16 v[220:221], v244 offset:1024
  ds_read_b64_tr_b16 v[222:223], v244 offset:1536
  s_waitcnt lgkmcnt(6)
  v_mfma_f32_16x16x32_bf16 v[192:195], v[224:227], v[168:171], v[192:195]
  s_add_u32 m0, s69, 99328
  s_add_u32 s64, s73, 270336
  buffer_load_dwordx4 v243, s[40:43], s64 offen lds
  v_mfma_f32_16x16x32_bf16 v[196:199], v[224:227], v[172:175], v[196:199]
  v_mfma_f32_16x16x32_bf16 v[200:203], v[224:227], v[176:179], v[200:203]
  ds_read_b64_tr_b16 v[224:225], v244 offset:2048
  ds_read_b64_tr_b16 v[226:227], v244 offset:2560
  s_waitcnt lgkmcnt(6)
  v_mfma_f32_16x16x32_bf16 v[192:195], v[228:231], v[180:183], v[192:195]
  s_add_u32 m0, s69, 100352
  s_add_u32 s64, s73, 278528
  buffer_load_dwordx4 v243, s[40:43], s64 offen lds
  v_mfma_f32_16x16x32_bf16 v[196:199], v[228:231], v[184:187], v[196:199]
  v_mfma_f32_16x16x32_bf16 v[200:203], v[228:231], v[188:191], v[200:203]
  ds_read_b64_tr_b16 v[228:229], v244 offset:3072
  ds_read_b64_tr_b16 v[230:231], v244 offset:3584
  s_waitcnt lgkmcnt(6)
  v_mfma_f32_16x16x32_bf16 v[204:207], v[216:219], v[0:3], 0
  s_add_u32 m0, s69, 101376
  s_add_u32 s64, s73, 286720
  buffer_load_dwordx4 v243, s[40:43], s64 offen lds
  v_mfma_f32_16x16x32_bf16 v[208:211], v[216:219], v[4:7], 0
  v_mfma_f32_16x16x32_bf16 v[212:215], v[216:219], v[8:11], 0
  ds_read_b64_tr_b16 v[216:217], v244 offset:16384
  ds_read_b64_tr_b16 v[218:219], v244 offset:16896
  s_waitcnt lgkmcnt(6)
  v_mfma_f32_16x16x32_bf16 v[204:207], v[220:223], v[12:15], v[204:207]
  s_waitcnt vmcnt(8)
  v_mov_b32 v249, 8
  s_lshl_b32 s65, s17, 7
  s_add_u32 s65, s65, s23
  s_mov_b64 exec, 1
  buffer_atomic_add v249, off, s[48:51], s65 sc1
  s_mov_b64 exec, -1
  v_mfma_f32_16x16x32_bf16 v[208:211], v[220:223], v[16:19], v[208:211]
  v_mfma_f32_16x16x32_bf16 v[212:215], v[220:223], v[20:23], v[212:215]
  ds_read_b64_tr_b16 v[220:221], v244 offset:17408
  ds_read_b64_tr_b16 v[222:223], v244 offset:17920
  s_waitcnt lgkmcnt(6)
  v_mfma_f32_16x16x32_bf16 v[204:207], v[224:227], v[24:27], v[204:207]
  v_cvt_pk_bf16_f32 v234, v192, v193
  v_cvt_pk_bf16_f32 v235, v194, v195
  v_cvt_pk_bf16_f32 v236, v196, v197
  v_cvt_pk_bf16_f32 v237, v198, v199
  v_cvt_pk_bf16_f32 v238, v200, v201
  v_cvt_pk_bf16_f32 v239, v202, v203
  s_mul_i32 s65, s18, 98304
  s_add_u32 s65, s65, s22
  buffer_store_dwordx4 v[234:237], v247, s[48:51], s65 offen sc1
  buffer_store_dwordx2 v[238:239], v253, s[48:51], s65 offen offset:1024 sc1
  v_mfma_f32_16x16x32_bf16 v[208:211], v[224:227], v[28:31], v[208:211]
  v_mfma_f32_16x16x32_bf16 v[212:215], v[224:227], v[32:35], v[212:215]
  ds_read_b64_tr_b16 v[224:225], v244 offset:18432
  ds_read_b64_tr_b16 v[226:227], v244 offset:18944
  s_waitcnt lgkmcnt(6)
  v_mfma_f32_16x16x32_bf16 v[204:207], v[228:231], v[36:39], v[204:207]
  v_mfma_f32_16x16x32_bf16 v[208:211], v[228:231], v[40:43], v[208:211]
  v_mfma_f32_16x16x32_bf16 v[212:215], v[228:231], v[44:47], v[212:215]
  ds_read_b64_tr_b16 v[228:229], v244 offset:19456
  ds_read_b64_tr_b16 v[230:231], v244 offset:19968
  s_waitcnt lgkmcnt(6)
  v_mfma_f32_16x16x32_bf16 v[204:207], v[216:219], v[48:51], v[204:207]
  v_mfma_f32_16x16x32_bf16 v[208:211], v[216:219], v[52:55], v[208:211]
  v_mfma_f32_16x16x32_bf16 v[212:215], v[216:219], v[56:59], v[212:215]
  s_barrier
  ds_read_b64_tr_b16 v[216:217], v244 offset:32768
  ds_read_b64_tr_b16 v[218:219], v244 offset:33280
  s_waitcnt lgkmcnt(6)
  v_mfma_f32_16x16x32_bf16 v[204:207], v[220:223], v[60:63], v[204:207]
  s_lshl_b32 s73, s21, 7
  s_add_u32 m0, s69, 131072
  s_add_u32 s64, s73, 0
  buffer_load_dwordx4 v243, s[40:43], s64 offen lds
  v_mfma_f32_16x16x32_bf16 v[208:211], v[220:223], v[64:67], v[208:211]
  v_mfma_f32_16x16x32_bf16 v[212:215], v[220:223], v[68:71], v[212:215]
  ds_read_b64_tr_b16 v[220:221], v244 offset:33792
  ds_read_b64_tr_b16 v[222:223], v244 offset:34304
  s_waitcnt lgkmcnt(6)
  v_mfma_f32_16x16x32_bf16 v[204:207], v[224:227], v[72:75], v[204:207]
  s_add_u32 m0, s69, 132096
  s_add_u32 s64, s73, 8192
  buffer_load_dwordx4 v243, s[40:43], s64 offen lds
  v_mfma_f32_16x16x32_bf16 v[208:211], v[224:227], v[76:79], v[208:211]
  v_mfma_f32_16x16x32_bf16 v[212:215], v[224:227], v[80:83], v[212:215]
  ds_read_b64_tr_b16 v[224:225], v244 offset:34816
  ds_read_b64_tr_b16 v[226:227], v244 offset:35328
  s_waitcnt lgkmcnt(6)
  v_mfma_f32_16x16x32_bf16 v[204:207], v[228:231], v[84:87], v[204:207]
  s_add_u32 m0, s69, 133120
  s_add_u32 s64, s73, 16384
  buffer_load_dwordx4 v243, s[40:43], s64 offen lds
  v_mfma_f32_16x16x32_bf16 v[208:211], v[228:231], v[88:91], v[208:211]
  v_mfma_f32_16x16x32_bf16 v[212:215], v[228:231], v[92:95], v[212:215]
  ds_read_b64_tr_b16 v[228:229], v244 offset:35840
  ds_read_b64_tr_b16 v[230:231], v244 offset:36352
  s_waitcnt lgkmcnt(6)
  v_mfma_f32_16x16x32_bf16 v[204:207], v[216:219], v[96:99], v[204:207]
  s_add_u32 m0, s69, 134144
  s_add_u32 s64, s73, 24576
  buffer_load_dwordx4 v243, s[40:43], s64 offen lds
  v_mfma_f32_16x16x32_bf16 v[208:211], v[216:219], v[100:103], v[208:211]
  v_mfma_f32_16x16x32_bf16 v[212:215], v[216:219], v[104:107], v[212:215]
  ds_read_b64_tr_b16 v[216:217], v244 offset:49152
  ds_read_b64_tr_b16 v[218:219], v244 offset:49664
  s_waitcnt lgkmcnt(6)
  v_mfma_f32_16x16x32_bf16 v[204:207], v[220:223], v[108:111], v[204:207]
  v_mfma_f32_16x16x32_bf16 v[208:211], v[220:223], v[112:115], v[208:211]
  v_mfma_f32_16x16x32_bf16 v[212:215], v[220:223], v[116:119], v[212:215]
  ds_read_b64_tr_b16 v[220:221], v244 offset:50176
  ds_read_b64_tr_b16 v[222:223], v244 offset:50688
  s_waitcnt lgkmcnt(6)
  v_mfma_f32_16x16x32_bf16 v[204:207], v[224:227], v[120:123], v[204:207]
  v_mfma_f32_16x16x32_bf16 v[208:211], v[224:227], v[124:127], v[208:211]
  v_mfma_f32_16x16x32_bf16 v[212:215], v[224:227], v[128:131], v[212:215]
  ds_read_b64_tr_b16 v[224:225], v244 offset:51200
  ds_read_b64_tr_b16 v[226:227], v244 offset:51712
  s_waitcnt lgkmcnt(6)
  v_mfma_f32_16x16x32_bf16 v[204:207], v[228:231], v[132:135], v[204:207]
  v_mfma_f32_16x16x32_bf16 v[208:211], v[228:231], v[136:139], v[208:211]
  v_mfma_f32_16x16x32_bf16 v[212:215], v[228:231], v[140:143], v[212:215]
  ds_read_b64_tr_b16 v[228:229], v244 offset:52224
  ds_read_b64_tr_b16 v[230:231], v244 offset:52736
  s_waitcnt lgkmcnt(6)
  v_mfma_f32_16x16x32_bf16 v[204:207], v[216:219], v[144:147], v[204:207]
  v_mfma_f32_16x16x32_bf16 v[208:211], v[216:219], v[148:151], v[208:211]
  v_mfma_f32_16x16x32_bf16 v[212:215], v[216:219], v[152:155], v[212:215]
  s_waitcnt vmcnt(11)
  s_barrier
  ds_read_b64_tr_b16 v[216:217], v245 offset:0
  ds_read_b64_tr_b16 v[218:219], v245 offset:512
  s_waitcnt lgkmcnt(6)
  v_mfma_f32_16x16x32_bf16 v[204:207], v[220:223], v[156:159], v[204:207]
  s_lshl_b32 s73, s21, 7
  s_add_u32 m0, s69, 0
  s_add_u32 s64, s73, 262144
  buffer_load_dwordx4 v243, s[40:43], s64 offen lds
  v_mfma_f32_16x16x32_bf16 v[208:211], v[220:223], v[160:163], v[208:211]
  v_mfma_f32_16x16x32_bf16 v[212:215], v[220:223], v[164:167], v[212:215]
  ds_read_b64_tr_b16 v[220:221], v245 offset:1024
  ds_read_b64_tr_b16 v[222:223], v245 offset:1536
  s_waitcnt lgkmcnt(6)
  v_mfma_f32_16x16x32_bf16 v[204:207], v[224:227], v[168:171], v[204:207]
  s_add_u32 m0, s69, 1024
  s_add_u32 s64, s73, 270336
  buffer_load_dwordx4 v243, s[40:43], s64 offen lds
  v_mfma_f32_16x16x32_bf16 v[208:211], v[224:227], v[172:175], v[208:211]
  v_mfma_f32_16x16x32_bf16 v[212:215], v[224:227], v[176:179], v[212:215]
  ds_read_b64_tr_b16 v[224:225], v245 offset:2048
  ds_read_b64_tr_b16 v[226:227], v245 offset:2560
  s_waitcnt lgkmcnt(6)
  v_mfma_f32_16x16x32_bf16 v[204:207], v[228:231], v[180:183], v[204:207]
  s_add_u32 m0, s69, 2048
  s_add_u32 s64, s73, 278528
  buffer_load_dwordx4 v243, s[40:43], s64 offen lds
  v_mfma_f32_16x16x32_bf16 v[208:211], v[228:231], v[184:187], v[208:211]
  v_mfma_f32_16x16x32_bf16 v[212:215], v[228:231], v[188:191], v[212:215]
  ds_read_b64_tr_b16 v[228:229], v245 offset:3072
  ds_read_b64_tr_b16 v[230:231], v245 offset:3584
  s_waitcnt lgkmcnt(6)
  v_mfma_f32_16x16x32_bf16 v[192:195], v[216:219], v[0:3], 0
  s_add_u32 m0, s69, 3072
  s_add_u32 s64, s73, 286720
  buffer_load_dwordx4 v243, s[40:43], s64 offen lds
  v_mfma_f32_16x16x32_bf16 v[196:199], v[216:219], v[4:7], 0
  v_mfma_f32_16x16x32_bf16 v[200:203], v[216:219], v[8:11], 0
  ds_read_b64_tr_b16 v[216:217], v245 offset:16384
  ds_read_b64_tr_b16 v[218:219], v245 offset:16896
  s_waitcnt lgkmcnt(6)
  v_mfma_f32_16x16x32_bf16 v[192:195], v[220:223], v[12:15], v[192:195]
  s_waitcnt vmcnt(8)
  v_mov_b32 v249, 16
  s_lshl_b32 s65, s18, 7
  s_add_u32 s65, s65, s23
  s_mov_b64 exec, 1
  buffer_atomic_add v249, off, s[48:51], s65 sc1
  s_mov_b64 exec, -1
  v_mfma_f32_16x16x32_bf16 v[196:199], v[220:223], v[16:19], v[196:199]
  v_mfma_f32_16x16x32_bf16 v[200:203], v[220:223], v[20:23], v[200:203]
  ds_read_b64_tr_b16 v[220:221], v245 offset:17408
  ds_read_b64_tr_b16 v[222:223], v245 offset:17920
  s_waitcnt lgkmcnt(6)
  v_mfma_f32_16x16x32_bf16 v[192:195], v[224:227], v[24:27], v[192:195]
  v_cvt_pk_bf16_f32 v234, v204, v205
  v_cvt_pk_bf16_f32 v235, v206, v207
  v_cvt_pk_bf16_f32 v236, v208, v209
  v_cvt_pk_bf16_f32 v237, v210, v211
  v_cvt_pk_bf16_f32 v238, v212, v213
  v_cvt_pk_bf16_f32 v239, v214, v215
  s_mul_i32 s65, s19, 98304
  s_add_u32 s65, s65, s22
  buffer_store_dwordx4 v[234:237], v247, s[48:51], s65 offen sc1
  buffer_store_dwordx2 v[238:239], v253, s[48:51], s65 offen offset:1024 sc1
  v_mfma_f32_16x16x32_bf16 v[196:199], v[224:227], v[28:31], v[196:199]
  v_mfma_f32_16x16x32_bf16 v[200:203], v[224:227], v[32:35], v[200:203]
  ds_read_b64_tr_b16 v[224:225], v245 offset:18432
  ds_read_b64_tr_b16 v[226:227], v245 offset:18944
  s_waitcnt lgkmcnt(6)
  v_mfma_f32_16x16x32_bf16 v[192:195], v[228:231], v[36:39], v[192:195]
  v_mfma_f32_16x16x32_bf16 v[196:199], v[228:231], v[40:43], v[196:199]
  v_mfma_f32_16x16x32_bf16 v[200:203], v[228:231], v[44:47], v[200:203]
  ds_read_b64_tr_b16 v[228:229], v245 offset:19456
  ds_read_b64_tr_b16 v[230:231], v245 offset:19968
  s_waitcnt lgkmcnt(6)
  v_mfma_f32_16x16x32_bf16 v[192:195], v[216:219], v[48:51], v[192:195]
  v_mfma_f32_16x16x32_bf16 v[196:199], v[216:219], v[52:55], v[196:199]
  v_mfma_f32_16x16x32_bf16 v[200:203], v[216:219], v[56:59], v[200:203]
  s_barrier
  ds_read_b64_tr_b16 v[216:217], v245 offset:32768
  ds_read_b64_tr_b16 v[218:219], v245 offset:33280
  s_waitcnt lgkmcnt(6)
  v_mfma_f32_16x16x32_bf16 v[192:195], v[220:223], v[60:63], v[192:195]
  v_mfma_f32_16x16x32_bf16 v[196:199], v[220:223], v[64:67], v[196:199]
  v_mfma_f32_16x16x32_bf16 v[200:203], v[220:223], v[68:71], v[200:203]
  ds_read_b64_tr_b16 v[220:221], v245 offset:33792
  ds_read_b64_tr_b16 v[222:223], v245 offset:34304
  s_waitcnt lgkmcnt(6)
  v_mfma_f32_16x16x32_bf16 v[192:195], v[224:227], v[72:75], v[192:195]
  v_mfma_f32_16x16x32_bf16 v[196:199], v[224:227], v[76:79], v[196:199]
  v_mfma_f32_16x16x32_bf16 v[200:203], v[224:227], v[80:83], v[200:203]
  ds_read_b64_tr_b16 v[224:225], v245 offset:34816
  ds_read_b64_tr_b16 v[226:227], v245 offset:35328
  s_waitcnt lgkmcnt(6)
  v_mfma_f32_16x16x32_bf16 v[192:195], v[228:231], v[84:87], v[192:195]
  v_mfma_f32_16x16x32_bf16 v[196:199], v[228:231], v[88:91], v[196:199]
  v_mfma_f32_16x16x32_bf16 v[200:203], v[228:231], v[92:95], v[200:203]
  ds_read_b64_tr_b16 v[228:229], v245 offset:35840
  ds_read_b64_tr_b16 v[230:231], v245 offset:36352
  s_waitcnt lgkmcnt(6)
  v_mfma_f32_16x16x32_bf16 v[192:195], v[216:219], v[96:99], v[192:195]
  v_mfma_f32_16x16x32_bf16 v[196:199], v[216:219], v[100:103], v[196:199]
  v_mfma_f32_16x16x32_bf16 v[200:203], v[216:219], v[104:107], v[200:203]
  ds_read_b64_tr_b16 v[216:217], v245 offset:49152
  ds_read_b64_tr_b16 v[218:219], v245 offset:49664
  s_waitcnt lgkmcnt(6)
  v_mfma_f32_16x16x32_bf16 v[192:195], v[220:223], v[108:111], v[192:195]
  v_mfma_f32_16x16x32_bf16 v[196:199], v[220:223], v[112:115], v[196:199]
  v_mfma_f32_16x16x32_bf16 v[200:203], v[220:223], v[116:119], v[200:203]
  ds_read_b64_tr_b16 v[220:221], v245 offset:50176
  ds_read_b64_tr_b16 v[222:223], v245 offset:50688
  s_waitcnt lgkmcnt(6)
  v_mfma_f32_16x16x32_bf16 v[192:195], v[224:227], v[120:123], v[192:195]
  v_mfma_f32_16x16x32_bf16 v[196:199], v[224:227], v[124:127], v[196:199]
  v_mfma_f32_16x16x32_bf16 v[200:203], v[224:227], v[128:131], v[200:203]
  ds_read_b64_tr_b16 v[224:225], v245 offset:51200
  ds_read_b64_tr_b16 v[226:227], v245 offset:51712
  s_waitcnt lgkmcnt(6)
  v_mfma_f32_16x16x32_bf16 v[192:195], v[228:231], v[132:135], v[192:195]
  v_mfma_f32_16x16x32_bf16 v[196:199], v[228:231], v[136:139], v[196:199]
  v_mfma_f32_16x16x32_bf16 v[200:203], v[228:231], v[140:143], v[200:203]
  ds_read_b64_tr_b16 v[228:229], v245 offset:52224
  ds_read_b64_tr_b16 v[230:231], v245 offset:52736
  s_waitcnt lgkmcnt(6)
  v_mfma_f32_16x16x32_bf16 v[192:195], v[216:219], v[144:147], v[192:195]
  v_mfma_f32_16x16x32_bf16 v[196:199], v[216:219], v[148:151], v[196:199]
  v_mfma_f32_16x16x32_bf16 v[200:203], v[216:219], v[152:155], v[200:203]
  s_waitcnt vmcnt(7)
  s_barrier
  ds_read_b64_tr_b16 v[216:217], v246 offset:0
  ds_read_b64_tr_b16 v[218:219], v246 offset:512
  s_waitcnt lgkmcnt(6)
  v_mfma_f32_16x16x32_bf16 v[192:195], v[220:223], v[156:159], v[192:195]
  s_waitcnt vmcnt(0)
  v_mov_b32 v249, 32
  s_lshl_b32 s65, s19, 7
  s_add_u32 s65, s65, s23
  s_mov_b64 exec, 1
  buffer_atomic_add v249, off, s[48:51], s65 sc1
  s_mov_b64 exec, -1
  v_mfma_f32_16x16x32_bf16 v[196:199], v[220:223], v[160:163], v[196:199]
  v_mfma_f32_16x16x32_bf16 v[200:203], v[220:223], v[164:167], v[200:203]
  ds_read_b64_tr_b16 v[220:221], v246 offset:1024
  ds_read_b64_tr_b16 v[222:223], v246 offset:1536
  s_waitcnt lgkmcnt(6)
  v_mfma_f32_16x16x32_bf16 v[192:195], v[224:227], v[168:171], v[192:195]
  v_mfma_f32_16x16x32_bf16 v[196:199], v[224:227], v[172:175], v[196:199]
  v_mfma_f32_16x16x32_bf16 v[200:203], v[224:227], v[176:179], v[200:203]
  ds_read_b64_tr_b16 v[224:225], v246 offset:2048
  ds_read_b64_tr_b16 v[226:227], v246 offset:2560
  s_waitcnt lgkmcnt(6)
  v_mfma_f32_16x16x32_bf16 v[192:195], v[228:231], v[180:183], v[192:195]
  v_mfma_f32_16x16x32_bf16 v[196:199], v[228:231], v[184:187], v[196:199]
  v_mfma_f32_16x16x32_bf16 v[200:203], v[228:231], v[188:191], v[200:203]
  ds_read_b64_tr_b16 v[228:229], v246 offset:3072
  ds_read_b64_tr_b16 v[230:231], v246 offset:3584
  s_waitcnt lgkmcnt(6)
  v_mfma_f32_16x16x32_bf16 v[204:207], v[216:219], v[0:3], 0
  buffer_load_dword v248, off, s[48:51], s13 sc1
  v_mfma_f32_16x16x32_bf16 v[208:211], v[216:219], v[4:7], 0
  v_mfma_f32_16x16x32_bf16 v[212:215], v[216:219], v[8:11], 0
  ds_read_b64_tr_b16 v[216:217], v246 offset:16384
  ds_read_b64_tr_b16 v[218:219], v246 offset:16896
  s_waitcnt lgkmcnt(6)
  v_mfma_f32_16x16x32_bf16 v[204:207], v[220:223], v[12:15], v[204:207]
  v_cvt_pk_bf16_f32 v234, v192, v193
  v_cvt_pk_bf16_f32 v235, v194, v195
  v_cvt_pk_bf16_f32 v236, v196, v197
  v_cvt_pk_bf16_f32 v237, v198, v199
  v_cvt_pk_bf16_f32 v238, v200, v201
  v_cvt_pk_bf16_f32 v239, v202, v203
  s_mul_i32 s65, s20, 98304
  s_add_u32 s65, s65, s22
  buffer_store_dwordx4 v[234:237], v247, s[48:51], s65 offen sc1
  buffer_store_dwordx2 v[238:239], v253, s[48:51], s65 offen offset:1024 sc1
  v_mfma_f32_16x16x32_bf16 v[208:211], v[220:223], v[16:19], v[208:211]
  v_mfma_f32_16x16x32_bf16 v[212:215], v[220:223], v[20:23], v[212:215]
  ds_read_b64_tr_b16 v[220:221], v246 offset:17408
  ds_read_b64_tr_b16 v[222:223], v246 offset:17920
  s_waitcnt lgkmcnt(6)
  v_mfma_f32_16x16x32_bf16 v[204:207], v[224:227], v[24:27], v[204:207]
  v_mfma_f32_16x16x32_bf16 v[208:211], v[224:227], v[28:31], v[208:211]
  v_mfma_f32_16x16x32_bf16 v[212:215], v[224:227], v[32:35], v[212:215]
  ds_read_b64_tr_b16 v[224:225], v246 offset:18432
  ds_read_b64_tr_b16 v[226:227], v246 offset:18944
  s_waitcnt lgkmcnt(6)
  v_mfma_f32_16x16x32_bf16 v[204:207], v[228:231], v[36:39], v[204:207]
  v_mfma_f32_16x16x32_bf16 v[208:211], v[228:231], v[40:43], v[208:211]
  v_mfma_f32_16x16x32_bf16 v[212:215], v[228:231], v[44:47], v[212:215]
  ds_read_b64_tr_b16 v[228:229], v246 offset:19456
  ds_read_b64_tr_b16 v[230:231], v246 offset:19968
  s_waitcnt lgkmcnt(6)
  v_mfma_f32_16x16x32_bf16 v[204:207], v[216:219], v[48:51], v[204:207]
  v_mfma_f32_16x16x32_bf16 v[208:211], v[216:219], v[52:55], v[208:211]
  v_mfma_f32_16x16x32_bf16 v[212:215], v[216:219], v[56:59], v[212:215]
  s_barrier
  ds_read_b64_tr_b16 v[216:217], v244 offset:0
  ds_read_b64_tr_b16 v[218:219], v244 offset:512
  s_waitcnt lgkmcnt(6)
  v_mfma_f32_16x16x32_bf16 v[204:207], v[220:223], v[60:63], v[204:207]
  v_mfma_f32_16x16x32_bf16 v[208:211], v[220:223], v[64:67], v[208:211]
  v_mfma_f32_16x16x32_bf16 v[212:215], v[220:223], v[68:71], v[212:215]
  ds_read_b64_tr_b16 v[220:221], v244 offset:1024
  ds_read_b64_tr_b16 v[222:223], v244 offset:1536
  s_waitcnt lgkmcnt(6)
  v_mfma_f32_16x16x32_bf16 v[204:207], v[224:227], v[72:75], v[204:207]
  v_mfma_f32_16x16x32_bf16 v[208:211], v[224:227], v[76:79], v[208:211]
  v_mfma_f32_16x16x32_bf16 v[212:215], v[224:227], v[80:83], v[212:215]
  ds_read_b64_tr_b16 v[224:225], v244 offset:2048
  ds_read_b64_tr_b16 v[226:227], v244 offset:2560
  s_waitcnt lgkmcnt(6)
  v_mfma_f32_16x16x32_bf16 v[204:207], v[228:231], v[84:87], v[204:207]
  v_mfma_f32_16x16x32_bf16 v[208:211], v[228:231], v[88:91], v[208:211]
  v_mfma_f32_16x16x32_bf16 v[212:215], v[228:231], v[92:95], v[212:215]
  ds_read_b64_tr_b16 v[228:229], v244 offset:3072
  ds_read_b64_tr_b16 v[230:231], v244 offset:3584
  s_waitcnt lgkmcnt(6)
  v_mfma_f32_16x16x32_bf16 v[204:207], v[216:219], v[96:99], v[204:207]
  v_mfma_f32_16x16x32_bf16 v[208:211], v[216:219], v[100:103], v[208:211]
  v_mfma_f32_16x16x32_bf16 v[212:215], v[216:219], v[104:107], v[212:215]
  ds_read_b64_tr_b16 v[216:217], v244 offset:16384
  ds_read_b64_tr_b16 v[218:219], v244 offset:16896
  s_waitcnt lgkmcnt(6)
  v_mfma_f32_16x16x32_bf16 v[204:207], v[220:223], v[108:111], v[204:207]
  v_mfma_f32_16x16x32_bf16 v[208:211], v[220:223], v[112:115], v[208:211]
  v_mfma_f32_16x16x32_bf16 v[212:215], v[220:223], v[116:119], v[212:215]
  ds_read_b64_tr_b16 v[220:221], v244 offset:17408
  ds_read_b64_tr_b16 v[222:223], v244 offset:17920
  s_waitcnt lgkmcnt(6)
  v_mfma_f32_16x16x32_bf16 v[204:207], v[224:227], v[120:123], v[204:207]
  s_waitcnt vmcnt(0)
  v_mov_b32 v249, 64
  s_lshl_b32 s65, s20, 7
  s_add_u32 s65, s65, s23
  s_mov_b64 exec, 1
  buffer_atomic_add v249, off, s[48:51], s65 sc1
  s_mov_b64 exec, -1
  v_mfma_f32_16x16x32_bf16 v[208:211], v[224:227], v[124:127], v[208:211]
  v_mfma_f32_16x16x32_bf16 v[212:215], v[224:227], v[128:131], v[212:215]
  ds_read_b64_tr_b16 v[224:225], v244 offset:18432
  ds_read_b64_tr_b16 v[226:227], v244 offset:18944
  s_waitcnt lgkmcnt(6)
  v_mfma_f32_16x16x32_bf16 v[204:207], v[228:231], v[132:135], v[204:207]
  v_mfma_f32_16x16x32_bf16 v[208:211], v[228:231], v[136:139], v[208:211]
  v_mfma_f32_16x16x32_bf16 v[212:215], v[228:231], v[140:143], v[212:215]
  ds_read_b64_tr_b16 v[228:229], v244 offset:19456
  ds_read_b64_tr_b16 v[230:231], v244 offset:19968
  s_waitcnt lgkmcnt(6)
  v_mfma_f32_16x16x32_bf16 v[204:207], v[216:219], v[144:147], v[204:207]
  v_mfma_f32_16x16x32_bf16 v[208:211], v[216:219], v[148:151], v[208:211]
  v_mfma_f32_16x16x32_bf16 v[212:215], v[216:219], v[152:155], v[212:215]
  s_barrier
  s_waitcnt lgkmcnt(4)
  v_mfma_f32_16x16x32_bf16 v[204:207], v[220:223], v[156:159], v[204:207]
  v_readfirstlane_b32 s3, v248
  s_nop 3
  s_and_b32 s3, s3, 15
  s_bitcmp0_b32 s3, 0
  s_cbranch_scc1 Ler0
  s_lshl_b32 s66, s57, 1
  s_sub_u32 s66, s66, s14
  s_and_b32 s66, s66, 7
  s_mul_i32 s66, s66, 12288
  s_add_u32 s66, s66, s12
  buffer_load_dwordx4 v[0:3], v247, s[48:51], s66 offen sc1
  buffer_load_dwordx2 v[4:5], v253, s[48:51], s66 offen offset:1024 sc1
Ler0:
  s_bitcmp0_b32 s3, 1
  s_cbranch_scc1 Ler1
  s_lshl_b32 s66, s57, 1
  s_sub_u32 s66, s66, s15
  s_and_b32 s66, s66, 7
  s_mul_i32 s66, s66, 12288
  s_add_u32 s66, s66, s12
  buffer_load_dwordx4 v[8:11], v247, s[48:51], s66 offen sc1
  buffer_load_dwordx2 v[12:13], v253, s[48:51], s66 offen offset:1024 sc1
Ler1:
  v_mfma_f32_16x16x32_bf16 v[208:211], v[220:223], v[160:163], v[208:211]
  v_mfma_f32_16x16x32_bf16 v[212:215], v[220:223], v[164:167], v[212:215]
  s_waitcnt lgkmcnt(2)
  v_mfma_f32_16x16x32_bf16 v[204:207], v[224:227], v[168:171], v[204:207]
  s_bitcmp0_b32 s3, 2
  s_cbranch_scc1 Ler2
  s_lshl_b32 s66, s57, 1
  s_sub_u32 s66, s66, s16
  s_and_b32 s66, s66, 7
  s_mul_i32 s66, s66, 12288
  s_add_u32 s66, s66, s12
  buffer_load_dwordx4 v[16:19], v247, s[48:51], s66 offen sc1
  buffer_load_dwordx2 v[20:21], v253, s[48:51], s66 offen offset:1024 sc1
Ler2:
  s_bitcmp0_b32 s3, 3
  s_cbranch_scc1 Ler3
  s_lshl_b32 s66, s57, 1
  s_sub_u32 s66, s66, s17
  s_and_b32 s66, s66, 7
  s_mul_i32 s66, s66, 12288
  s_add_u32 s66, s66, s12
  buffer_load_dwordx4 v[24:27], v247, s[48:51], s66 offen sc1
  buffer_load_dwordx2 v[28:29], v253, s[48:51], s66 offen offset:1024 sc1
Ler3:
  v_mfma_f32_16x16x32_bf16 v[208:211], v[224:227], v[172:175], v[208:211]
  v_mfma_f32_16x16x32_bf16 v[212:215], v[224:227], v[176:179], v[212:215]
  s_waitcnt lgkmcnt(0)
  v_mfma_f32_16x16x32_bf16 v[204:207], v[228:231], v[180:183], v[204:207]
  v_mfma_f32_16x16x32_bf16 v[208:211], v[228:231], v[184:187], v[208:211]
  v_mfma_f32_16x16x32_bf16 v[212:215], v[228:231], v[188:191], v[212:215]
  s_mov_b32 s73, 131072
Lp6:
  buffer_load_dword v248, off, s[48:51], s13 sc1
  s_waitcnt vmcnt(0)
  v_readfirstlane_b32 s64, v248
  s_nop 3
  s_and_b32 s64, s64, 127
  s_cmp_eq_u32 s64, 127
  s_cbranch_scc1 Lp6_ok
  s_sub_u32 s73, s73, 1
  s_cbranch_scc0 Lp6
Lp6_ok:
  s_bitcmp1_b32 s3, 0
  s_cbranch_scc1 Lh0
  s_lshl_b32 s66, s57, 1
  s_sub_u32 s66, s66, s14
  s_and_b32 s66, s66, 7
  s_mul_i32 s66, s66, 12288
  s_add_u32 s66, s66, s12
  buffer_load_dwordx4 v[0:3], v247, s[48:51], s66 offen sc1
  buffer_load_dwordx2 v[4:5], v253, s[48:51], s66 offen offset:1024 sc1
Lh0:
  s_bitcmp1_b32 s3, 1
  s_cbranch_scc1 Lh1
  s_lshl_b32 s66, s57, 1
  s_sub_u32 s66, s66, s15
  s_and_b32 s66, s66, 7
  s_mul_i32 s66, s66, 12288
  s_add_u32 s66, s66, s12
  buffer_load_dwordx4 v[8:11], v247, s[48:51], s66 offen sc1
  buffer_load_dwordx2 v[12:13], v253, s[48:51], s66 offen offset:1024 sc1
Lh1:
  s_bitcmp1_b32 s3, 2
  s_cbranch_scc1 Lh2
  s_lshl_b32 s66, s57, 1
  s_sub_u32 s66, s66, s16
  s_and_b32 s66, s66, 7
  s_mul_i32 s66, s66, 12288
  s_add_u32 s66, s66, s12
  buffer_load_dwordx4 v[16:19], v247, s[48:51], s66 offen sc1
  buffer_load_dwordx2 v[20:21], v253, s[48:51], s66 offen offset:1024 sc1
Lh2:
  s_bitcmp1_b32 s3, 3
  s_cbranch_scc1 Lh3
  s_lshl_b32 s66, s57, 1
  s_sub_u32 s66, s66, s17
  s_and_b32 s66, s66, 7
  s_mul_i32 s66, s66, 12288
  s_add_u32 s66, s66, s12
  buffer_load_dwordx4 v[24:27], v247, s[48:51], s66 offen sc1
  buffer_load_dwordx2 v[28:29], v253, s[48:51], s66 offen offset:1024 sc1
Lh3:
  s_lshl_b32 s66, s57, 1
  s_sub_u32 s66, s66, s18
  s_and_b32 s66, s66, 7
  s_mul_i32 s66, s66, 12288
  s_add_u32 s66, s66, s12
  buffer_load_dwordx4 v[32:35], v247, s[48:51], s66 offen sc1
  buffer_load_dwordx2 v[36:37], v253, s[48:51], s66 offen offset:1024 sc1
  s_lshl_b32 s66, s57, 1
  s_sub_u32 s66, s66, s19
  s_and_b32 s66, s66, 7
  s_mul_i32 s66, s66, 12288
  s_add_u32 s66, s66, s12
  buffer_load_dwordx4 v[40:43], v247, s[48:51], s66 offen sc1
  buffer_load_dwordx2 v[44:45], v253, s[48:51], s66 offen offset:1024 sc1
  s_lshl_b32 s66, s57, 1
  s_sub_u32 s66, s66, s20
  s_and_b32 s66, s66, 7
  s_mul_i32 s66, s66, 12288
  s_add_u32 s66, s66, s12
  buffer_load_dwordx4 v[48:51], v247, s[48:51], s66 offen sc1
  buffer_load_dwordx2 v[52:53], v253, s[48:51], s66 offen offset:1024 sc1
  s_waitcnt vmcnt(6)
  v_lshlrev_b32 v64, 16, v0
  v_and_b32 v65, s74, v0
  v_lshlrev_b32 v66, 16, v1
  v_and_b32 v67, s74, v1
  v_lshlrev_b32 v68, 16, v2
  v_and_b32 v69, s74, v2
  v_lshlrev_b32 v70, 16, v3
  v_and_b32 v71, s74, v3
  v_lshlrev_b32 v72, 16, v4
  v_and_b32 v73, s74, v4
  v_lshlrev_b32 v74, 16, v5
  v_and_b32 v75, s74, v5
  v_pk_add_f32 v[204:205], v[204:205], v[64:65]
  v_pk_add_f32 v[206:207], v[206:207], v[66:67]
  v_pk_add_f32 v[208:209], v[208:209], v[68:69]
  v_pk_add_f32 v[210:211], v[210:211], v[70:71]
  v_pk_add_f32 v[212:213], v[212:213], v[72:73]
  v_pk_add_f32 v[214:215], v[214:215], v[74:75]
  s_waitcnt vmcnt(6)
  v_lshlrev_b32 v64, 16, v8
  v_and_b32 v65, s74, v8
  v_lshlrev_b32 v66, 16, v9
  v_and_b32 v67, s74, v9
  v_lshlrev_b32 v68, 16, v10
  v_and_b32 v69, s74, v10
  v_lshlrev_b32 v70, 16, v11
  v_and_b32 v71, s74, v11
  v_lshlrev_b32 v72, 16, v12
  v_and_b32 v73, s74, v12
  v_lshlrev_b32 v74, 16, v13
  v_and_b32 v75, s74, v13
  v_pk_add_f32 v[204:205], v[204:205], v[64:65]
  v_pk_add_f32 v[206:207], v[206:207], v[66:67]
  v_pk_add_f32 v[208:209], v[208:209], v[68:69]
  v_pk_add_f32 v[210:211], v[210:211], v[70:71]
  v_pk_add_f32 v[212:213], v[212:213], v[72:73]
  v_pk_add_f32 v[214:215], v[214:215], v[74:75]
  s_waitcnt vmcnt(6)
  v_lshlrev_b32 v64, 16, v16
  v_and_b32 v65, s74, v16
  v_lshlrev_b32 v66, 16, v17
  v_and_b32 v67, s74, v17
  v_lshlrev_b32 v68, 16, v18
  v_and_b32 v69, s74, v18
  v_lshlrev_b32 v70, 16, v19
  v_and_b32 v71, s74, v19
  v_lshlrev_b32 v72, 16, v20
  v_and_b32 v73, s74, v20
  v_lshlrev_b32 v74, 16, v21
  v_and_b32 v75, s74, v21
  v_pk_add_f32 v[204:205], v[204:205], v[64:65]
  v_pk_add_f32 v[206:207], v[206:207], v[66:67]
  v_pk_add_f32 v[208:209], v[208:209], v[68:69]
  v_pk_add_f32 v[210:211], v[210:211], v[70:71]
  v_pk_add_f32 v[212:213], v[212:213], v[72:73]
  v_pk_add_f32 v[214:215], v[214:215], v[74:75]
  s_waitcnt vmcnt(6)
  v_lshlrev_b32 v64, 16, v24
  v_and_b32 v65, s74, v24
  v_lshlrev_b32 v66, 16, v25
  v_and_b32 v67, s74, v25
  v_lshlrev_b32 v68, 16, v26
  v_and_b32 v69, s74, v26
  v_lshlrev_b32 v70, 16, v27
  v_and_b32 v71, s74, v27
  v_lshlrev_b32 v72, 16, v28
  v_and_b32 v73, s74, v28
  v_lshlrev_b32 v74, 16, v29
  v_and_b32 v75, s74, v29
  v_pk_add_f32 v[204:205], v[204:205], v[64:65]
  v_pk_add_f32 v[206:207], v[206:207], v[66:67]
  v_pk_add_f32 v[208:209], v[208:209], v[68:69]
  v_pk_add_f32 v[210:211], v[210:211], v[70:71]
  v_pk_add_f32 v[212:213], v[212:213], v[72:73]
  v_pk_add_f32 v[214:215], v[214:215], v[74:75]
  s_waitcnt vmcnt(4)
  v_lshlrev_b32 v64, 16, v32
  v_and_b32 v65, s74, v32
  v_lshlrev_b32 v66, 16, v33
  v_and_b32 v67, s74, v33
  v_lshlrev_b32 v68, 16, v34
  v_and_b32 v69, s74, v34
  v_lshlrev_b32 v70, 16, v35
  v_and_b32 v71, s74, v35
  v_lshlrev_b32 v72, 16, v36
  v_and_b32 v73, s74, v36
  v_lshlrev_b32 v74, 16, v37
  v_and_b32 v75, s74, v37
  v_pk_add_f32 v[204:205], v[204:205], v[64:65]
  v_pk_add_f32 v[206:207], v[206:207], v[66:67]
  v_pk_add_f32 v[208:209], v[208:209], v[68:69]
  v_pk_add_f32 v[210:211], v[210:211], v[70:71]
  v_pk_add_f32 v[212:213], v[212:213], v[72:73]
  v_pk_add_f32 v[214:215], v[214:215], v[74:75]
  s_waitcnt vmcnt(2)
  v_lshlrev_b32 v64, 16, v40
  v_and_b32 v65, s74, v40
  v_lshlrev_b32 v66, 16, v41
  v_and_b32 v67, s74, v41
  v_lshlrev_b32 v68, 16, v42
  v_and_b32 v69, s74, v42
  v_lshlrev_b32 v70, 16, v43
  v_and_b32 v71, s74, v43
  v_lshlrev_b32 v72, 16, v44
  v_and_b32 v73, s74, v44
  v_lshlrev_b32 v74, 16, v45
  v_and_b32 v75, s74, v45
  v_pk_add_f32 v[204:205], v[204:205], v[64:65]
  v_pk_add_f32 v[206:207], v[206:207], v[66:67]
  v_pk_add_f32 v[208:209], v[208:209], v[68:69]
  v_pk_add_f32 v[210:211], v[210:211], v[70:71]
  v_pk_add_f32 v[212:213], v[212:213], v[72:73]
  v_pk_add_f32 v[214:215], v[214:215], v[74:75]
  s_waitcnt vmcnt(0)
  v_lshlrev_b32 v64, 16, v48
  v_and_b32 v65, s74, v48
  v_lshlrev_b32 v66, 16, v49
  v_and_b32 v67, s74, v49
  v_lshlrev_b32 v68, 16, v50
  v_and_b32 v69, s74, v50
  v_lshlrev_b32 v70, 16, v51
  v_and_b32 v71, s74, v51
  v_lshlrev_b32 v72, 16, v52
  v_and_b32 v73, s74, v52
  v_lshlrev_b32 v74, 16, v53
  v_and_b32 v75, s74, v53
  v_pk_add_f32 v[204:205], v[204:205], v[64:65]
  v_pk_add_f32 v[206:207], v[206:207], v[66:67]
  v_pk_add_f32 v[208:209], v[208:209], v[68:69]
  v_pk_add_f32 v[210:211], v[210:211], v[70:71]
  v_pk_add_f32 v[212:213], v[212:213], v[72:73]
  v_pk_add_f32 v[214:215], v[214:215], v[74:75]
  v_cvt_pk_bf16_f32 v0, v204, v205
  v_cvt_pk_bf16_f32 v1, v206, v207
  s_mov_b32 s64, 0
  buffer_store_dwordx2 v[0:1], v252, s[44:47], s64 offen
  v_cvt_pk_bf16_f32 v2, v208, v209
  v_cvt_pk_bf16_f32 v3, v210, v211
  s_mov_b32 s64, 32768
  buffer_store_dwordx2 v[2:3], v252, s[44:47], s64 offen
  v_cvt_pk_bf16_f32 v4, v212, v213
  v_cvt_pk_bf16_f32 v5, v214, v215
  s_mov_b32 s64, 65536
  buffer_store_dwordx2 v[4:5], v252, s[44:47], s64 offen
  s_waitcnt vmcnt(0)
Lend:
s_endpgm
.section .rodata,"a"
.p2align 6
.amdhsa_kernel concat_heads__mha_block_cached__gqa_block_cached__near_ridge_kernel
  .amdhsa_next_free_vgpr 256
  .amdhsa_next_free_sgpr 102
  .amdhsa_accum_offset 256
  .amdhsa_group_segment_fixed_size 0
  .amdhsa_kernarg_size 104
  .amdhsa_user_sgpr_count 2
  .amdhsa_user_sgpr_kernarg_segment_ptr 1
  .amdhsa_system_sgpr_workgroup_id_x 1
.end_amdhsa_kernel
```
